```python
import torch

def _softmax(x, axis=-1):
    return torch.softmax(x, dim=axis)
def _gelu(x):
    return torch.nn.functional.gelu(x, approximate="tanh")
def _silu(x):
    return torch.nn.functional.silu(x)
def _sigmoid(x):
    return torch.sigmoid(x)
def _layernorm(x, axis=-1, eps=1e-5):
    m = x.mean(dim=axis, keepdim=True)
    v = x.var(dim=axis, keepdim=True, unbiased=False)
    return (x - m) / torch.sqrt(v + eps)
def _scatter_add(tgt, idx, src, axis=0):
    return tgt.clone().index_add_(axis, idx, src)
def _segment_sum(src, seg, n):
    out = torch.zeros((n,) + src.shape[1:], dtype=src.dtype)
    return out.index_add_(0, seg, src)
def _pad(x, pw):
    flat = tuple(v for pair in reversed(pw) for v in pair)
    return torch.nn.functional.pad(x, flat)

kernel_name = 'gated_mix__sliding_block_cached__gqa_block_cached__decode'

def setup_inputs():

    _w = (lambda a: (lambda t: t.to(torch.bfloat16) if t.is_floating_point() else t)(torch.as_tensor(a)))
    def _A_setup():
        B, Sq, D = 2, 1, 576
        Hq, Hkv, Sk, Dh = 32, 16, 8192, 128
        assert Hq % Hkv == 0, (Hq, Hkv)
        return {
            "x": _w((lambda *s: torch.randn(*s, dtype=torch.bfloat16) * 0.05)(B, Sq, D)),
            "k_cache": _w((lambda *s: torch.randn(*s, dtype=torch.bfloat16) * 6.4)(B, Hkv, Sk, Dh)),
            "v_cache": _w((lambda *s: torch.randn(*s, dtype=torch.bfloat16) * 0.05)(B, Hkv, Sk, Dh)),
            "wq": _w((lambda *s: torch.randn(*s, dtype=torch.bfloat16) * 6.4)(D, Hq * Dh) * (D ** -0.5)),
            "wo": _w((lambda *s: torch.randn(*s, dtype=torch.bfloat16) * 0.05)(Hq * Dh, D) * ((Hq * Dh) ** -0.5)),
        }
    _A_in = _A_setup()

    def _B_setup():
        B, Sq, D = 2, 1, 576
        Hq, Hkv, Sk, Dh = 32, 16, 8192, 128
        assert Hq % Hkv == 0, (Hq, Hkv)
        return {
            "x": _w((lambda *s: torch.randn(*s, dtype=torch.bfloat16) * 0.05)(B, Sq, D)),
            "k_cache": _w((lambda *s: torch.randn(*s, dtype=torch.bfloat16) * 6.4)(B, Hkv, Sk, Dh)),
            "v_cache": _w((lambda *s: torch.randn(*s, dtype=torch.bfloat16) * 0.05)(B, Hkv, Sk, Dh)),
            "wq": _w((lambda *s: torch.randn(*s, dtype=torch.bfloat16) * 6.4)(D, Hq * Dh) * (D ** -0.5)),
            "wo": _w((lambda *s: torch.randn(*s, dtype=torch.bfloat16) * 0.05)(Hq * Dh, D) * ((Hq * Dh) ** -0.5)),
        }
    _B_in = _B_setup()

    return {
        "A_x": _A_in["x"],
        "A_k_cache": _A_in["k_cache"],
        "A_v_cache": _A_in["v_cache"],
        "A_wq": _A_in["wq"],
        "A_wo": _A_in["wo"],
        "B_x": _B_in["x"],
        "B_k_cache": _B_in["k_cache"],
        "B_v_cache": _B_in["v_cache"],
        "B_wq": _B_in["wq"],
        "B_wo": _B_in["wo"],
        "gate_w": _w((lambda *s: torch.randn(*s, dtype=torch.bfloat16) * 0.05)(576) * 16.0),
    }

def reference(A_x, A_k_cache, A_v_cache, A_wq, A_wo, B_x, B_k_cache, B_v_cache, B_wq, B_wo, gate_w):
    def _A_ref(x, k_cache, v_cache, wq, wo):
        B, Sq, D = x.shape
        Hq, Dh = 32, 128
        Hkv, Sk = k_cache.shape[1], k_cache.shape[2]
        W = min(4096, max(256, Sk // 4))
        rep = Hq // Hkv
        q = (lambda x, *d: x.permute(*d))((x @ wq).reshape(B, Sq, Hq, Dh), 0, 2, 1, 3)
        k = (lambda x, n, axis: torch.repeat_interleave(x, n, dim=axis))(k_cache[:, :, Sk - W:, :], rep, axis=1)
        v = (lambda x, n, axis: torch.repeat_interleave(x, n, dim=axis))(v_cache[:, :, Sk - W:, :], rep, axis=1)
        scores = torch.einsum("bhqd,bhkd->bhqk", q, k) * (Dh ** -0.5)
        p = _softmax(scores, axis=-1)
        o = torch.einsum("bhqk,bhkd->bhqd", p, v)
        return (lambda x, *d: x.permute(*d))(o, 0, 2, 1, 3).reshape(B, Sq, Hq * Dh) @ wo

    def _B_ref(x, k_cache, v_cache, wq, wo):
        B, Sq, D = x.shape
        Hq, Dh = 32, 128
        Hkv = k_cache.shape[1]
        rep = Hq // Hkv
        q = (lambda x, *d: x.permute(*d))((x @ wq).reshape(B, Sq, Hq, Dh), 0, 2, 1, 3)
        k = (lambda x, n, axis: torch.repeat_interleave(x, n, dim=axis))(k_cache, rep, axis=1)
        v = (lambda x, n, axis: torch.repeat_interleave(x, n, dim=axis))(v_cache, rep, axis=1)
        scores = torch.einsum("bhqd,bhkd->bhqk", q, k) * (Dh ** -0.5)
        p = _softmax(scores, axis=-1)
        o = torch.einsum("bhqk,bhkd->bhqd", p, v)
        return (lambda x, *d: x.permute(*d))(o, 0, 2, 1, 3).reshape(B, Sq, Hq * Dh) @ wo

    x = A_x
    g = _sigmoid((x * gate_w).sum(-1, keepdims=True))
    a = _A_ref(x, A_k_cache, A_v_cache, A_wq, A_wo)
    b = _B_ref(x, B_k_cache, B_v_cache, B_wq, B_wo)
    return g * a + (1 - g) * b
```

```asm
; @launch grid=(256,1,1) block=(512,1,1) lds=21504
.amdgcn_target "amdgcn-amd-amdhsa--gfx950"
.text
.globl gated_mix__sliding_block_cached__gqa_block_cached__decode_kernel
.p2align 8
.type gated_mix__sliding_block_cached__gqa_block_cached__decode_kernel,@function
gated_mix__sliding_block_cached__gqa_block_cached__decode_kernel:
  s_cmpk_ge_u32 s2, 256
  s_cbranch_scc1 L_end
  s_load_dwordx4 s[20:23], s[0:1], 24
  s_load_dwordx8 s[32:39], s[0:1], 64
  s_load_dwordx2 s[44:45], s[0:1], 8
  s_load_dwordx2 s[48:49], s[0:1], 16
  v_lshrrev_b32 v1, 6, v0
  s_lshr_b32 s14, s2, 4
  v_readfirstlane_b32 s3, v1
  s_and_b32 s6, s2, 3
  s_cmp_ge_u32 s3, 4
  s_cbranch_scc1 L_young
  s_lshl2_add_u32 s6, s14, s6
  s_lshl_b32 s6, s6, 7
  s_and_b32 s7, s2, 8
  s_lshl3_add_u32 s6, s7, s6
  v_lshrrev_b32 v4, 2, v0
  v_and_b32 v6, 3, v0
  v_lshl_add_u32 v6, v6, 4, s6
  v_lshl_add_u32 v5, v4, 16, v6
  s_mov_b32 s62, 4718592
  s_mov_b32 s63, 0x00020000
  s_setprio 2
  s_bitcmp1_b32 s2, 2
  s_waitcnt lgkmcnt(0)
  s_cselect_b32 s60, s32, s20
  s_cselect_b32 s61, s33, s21
  buffer_load_dwordx4 v[96:99], v5, s[60:63], 0 offen nt
  s_load_dwordx2 s[76:77], s[0:1], 0
  s_movk_i32 s7, 8192
  buffer_load_dwordx4 v[100:103], v5, s[60:63], s7 offen nt
  s_addk_i32 s7, 8192
  buffer_load_dwordx4 v[104:107], v5, s[60:63], s7 offen nt
  s_addk_i32 s7, 8192
  buffer_load_dwordx4 v[108:111], v5, s[60:63], s7 offen nt
  s_addk_i32 s7, 8192
  buffer_load_dwordx4 v[112:115], v5, s[60:63], s7 offen nt
  s_addk_i32 s7, 8192
  buffer_load_dwordx4 v[116:119], v5, s[60:63], s7 offen nt
  s_addk_i32 s7, 8192
  buffer_load_dwordx4 v[120:123], v5, s[60:63], s7 offen nt
  s_addk_i32 s7, 8192
  buffer_load_dwordx4 v[124:127], v5, s[60:63], s7 offen nt
  v_lshl_add_u32 v6, v4, 13, v6
  s_mov_b32 s7, 4194304
  buffer_load_dwordx4 v[128:131], v6, s[60:63], s7 offen nt
  v_lshlrev_b32 v7, 1, v4
  v_lshlrev_b32 v4, 4, v4
  v_mov_b32 v144, 0
  v_mov_b32 v145, 0
  s_movk_i32 s78, 2304
  s_mov_b32 s79, 0x00020000
  v_mov_b32 v8, 0
  v_mov_b32 v9, 0
  v_mov_b32 v10, 0
  v_mov_b32 v11, 0
  v_and_b32 v12, 63, v0
  v_lshlrev_b32 v12, 4, v12
  s_mov_b64 exec, 1
  v_mov_b32 v10, 4
  s_mov_b64 exec, 0x7f
  ds_write_b128 v12, v[8:11] offset:3072
  s_mov_b64 exec, -1
  s_waitcnt lgkmcnt(0)
  buffer_load_dwordx4 v[136:139], v4, s[76:79], 0 offen
  buffer_load_dwordx4 v[140:143], v4, s[76:79], 0 offen offset:1152
  buffer_load_short_d16_hi v144, v7, s[76:79], 0 offen offset:1024
  buffer_load_short_d16_hi v145, v7, s[76:79], 0 offen offset:2176
  s_barrier
  s_branch L_old2
L_ywait:
  v_mov_b32 v89, 0
  s_barrier
  s_mov_b32 s13, 3200000
L_spin_y:
  ds_read_b64 v[10:11], v89 offset:3088
  s_sub_u32 s13, s13, 1
  s_cbranch_scc1 L_ygo
  s_waitcnt lgkmcnt(0)
  v_readfirstlane_b32 s7, v11
  s_cmp_ge_u32 s7, s18
  s_cbranch_scc1 L_ygo
  s_sleep 1
  s_branch L_spin_y
.p2align 6
L_young:
  v_and_b32 v1, 48, v0
  v_bfe_u32 v8, v0, 2, 2
  v_lshl_add_u32 v1, v8, 8, v1
  v_and_b32 v8, 3, v0
  v_lshl_add_u32 v1, v8, 10, v1
  s_and_b32 s6, s2, 8
  s_lshl1_add_u32 s6, s6, s14
  s_lshl_b32 s73, s6, 21
  s_lshr_b32 s8, s2, 5
  s_xor_b32 s8, s8, s2
  s_and_b32 s8, s8, 7
  s_lshl_b32 s8, s8, 12
  s_or_b32 s5, s73, s8
  s_add_u32 s7, s3, 24
  s_lshl_b32 s7, s7, 16
  s_or_b32 s4, s5, s7
  s_and_b32 s7, s3, 1
  s_lshl_b32 s7, s7, 13
  s_xor_b32 s4, s4, s7
  s_mov_b32 s46, 0x4000000
  s_mov_b32 s47, 0x00020000
  s_setprio 2
  s_sub_u32 s18, s3, 4
  s_cmp_eq_u32 s18, 0
  s_cbranch_scc0 L_ywait
L_ygo:
  s_waitcnt lgkmcnt(0)
  s_xor_b32 s9, s4, 32768
  buffer_load_dwordx4 v[96:99], v1, s[44:47], s4 offen offset:0 nt
  buffer_load_dwordx4 v[100:103], v1, s[44:47], s4 offen offset:64 nt
  buffer_load_dwordx4 v[104:107], v1, s[44:47], s4 offen offset:128 nt
  buffer_load_dwordx4 v[108:111], v1, s[44:47], s4 offen offset:192 nt
  buffer_load_dwordx4 v[112:115], v1, s[44:47], s9 offen offset:0 nt
  buffer_load_dwordx4 v[116:119], v1, s[44:47], s9 offen offset:64 nt
  buffer_load_dwordx4 v[120:123], v1, s[44:47], s9 offen offset:128 nt
  buffer_load_dwordx4 v[124:127], v1, s[44:47], s9 offen offset:192 nt
  v_and_b32 v0, 63, v0
  v_lshlrev_b32 v2, 4, v0
  v_mov_b32 v89, 0
  s_mov_b64 s[50:51], s[46:47]
  buffer_load_dwordx4 v[128:131], v2, s[48:51], s4 offen offset:0 nt
  buffer_load_dwordx4 v[132:135], v2, s[48:51], s4 offen offset:1024 nt
  buffer_load_dwordx4 v[136:139], v2, s[48:51], s4 offen offset:2048 nt
  buffer_load_dwordx4 v[140:143], v2, s[48:51], s4 offen offset:3072 nt
  s_cmp_eq_u32 s18, 0
  s_cbranch_scc0 L_ynb
  s_barrier
L_ynb:
  s_mov_b64 exec, 1
  v_mov_b32 v90, 1
  ds_add_u32 v89, v90 offset:3092
  s_mov_b64 exec, -1
  buffer_load_dwordx4 v[144:147], v2, s[48:51], s9 offen offset:0 nt
  buffer_load_dwordx4 v[148:151], v2, s[48:51], s9 offen offset:1024 nt
  buffer_load_dwordx4 v[152:155], v2, s[48:51], s9 offen offset:2048 nt
  buffer_load_dwordx4 v[156:159], v2, s[48:51], s9 offen offset:3072 nt
  s_load_dwordx2 s[52:53], s[0:1], 48
  s_load_dwordx2 s[56:57], s[0:1], 56
  s_load_dwordx2 s[68:69], s[0:1], 104
  s_and_b32 s15, s2, 15
  s_and_b32 s6, s15, 7
  s_lshr_b32 s7, s15, 3
  s_lshl1_add_u32 s101, s6, s7
  s_lshr_b32 s74, s2, 3
  s_mul_i32 s74, s74, 4352
  s_add_u32 s74, s74, 720896
  s_mov_b32 s10, 0x3fb8aa3b
  s_mov_b32 s25, 0x3db504f3
  s_mov_b32 s11, 0x05040100
  s_mov_b32 s12, 0x07060302
  s_mov_b32 s54, 67108864
  s_mov_b32 s55, 0x00020000
  s_mov_b32 s58, 67108864
  s_mov_b32 s59, 0x00020000
  s_mov_b32 s70, 287315584
  s_mov_b32 s71, 0x00020000
  s_mov_b32 s66, 4718592
  s_mov_b32 s67, 0x00020000
  s_cmp_ge_u32 s15, 8
  s_cselect_b32 s64, s34, s22
  s_cselect_b32 s65, s35, s23
  s_branch L_afterA
L_old2:
  s_setprio 3
  s_load_dwordx2 s[52:53], s[0:1], 48
  s_load_dwordx2 s[56:57], s[0:1], 56
  s_load_dwordx2 s[68:69], s[0:1], 104
  v_and_b32 v1, 48, v0
  v_bfe_u32 v8, v0, 2, 2
  v_lshl_add_u32 v1, v8, 8, v1
  v_and_b32 v8, 3, v0
  v_lshl_add_u32 v1, v8, 10, v1
  s_and_b32 s6, s2, 8
  s_lshl1_add_u32 s6, s6, s14
  s_lshl_b32 s73, s6, 21
  s_lshr_b32 s8, s2, 5
  s_xor_b32 s8, s8, s2
  s_and_b32 s8, s8, 7
  s_lshl_b32 s8, s8, 12
  s_or_b32 s5, s73, s8
  s_add_u32 s7, s3, 24
  s_lshl_b32 s7, s7, 16
  s_or_b32 s4, s5, s7
  s_and_b32 s7, s3, 1
  s_lshl_b32 s7, s7, 13
  s_xor_b32 s4, s4, s7
  s_mov_b32 s46, 0x4000000
  s_mov_b32 s47, 0x00020000
  v_and_b32 v0, 63, v0
  v_lshlrev_b32 v2, 4, v0
  v_mov_b32 v89, 0
  s_mov_b64 s[50:51], s[46:47]
  s_and_b32 s15, s2, 15
  s_and_b32 s6, s15, 7
  s_lshr_b32 s7, s15, 3
  s_lshl1_add_u32 s101, s6, s7
  s_lshr_b32 s74, s2, 3
  s_mul_i32 s74, s74, 4352
  s_add_u32 s74, s74, 720896
  s_mov_b32 s10, 0x3fb8aa3b
  s_mov_b32 s25, 0x3db504f3
  s_mov_b32 s11, 0x05040100
  s_mov_b32 s12, 0x07060302
  s_mov_b32 s54, 67108864
  s_mov_b32 s55, 0x00020000
  s_mov_b32 s58, 67108864
  s_mov_b32 s59, 0x00020000
  s_mov_b32 s70, 287315584
  s_mov_b32 s71, 0x00020000
  s_mov_b32 s66, 4718592
  s_mov_b32 s67, 0x00020000
  s_cmp_ge_u32 s15, 8
  s_cselect_b32 s64, s34, s22
  s_cselect_b32 s65, s35, s23
  s_waitcnt lgkmcnt(0)
  s_load_dword s72, s[68:69], 0
  s_and_b32 s6, s2, 7
  s_or_b32 s6, s6, s3
  s_cbranch_scc1 L_qproj
  s_mov_b64 exec, 1
  v_mov_b32 v12, 216
  buffer_store_dword v12, off, s[68:71], s74 sc1
  s_mov_b64 exec, -1
L_qproj:
  s_waitcnt vmcnt(0)
  v_lshlrev_b32 v160, 16, v136
  v_and_b32 v162, 0xffff0000, v136
  v_lshlrev_b32 v164, 16, v137
  v_and_b32 v166, 0xffff0000, v137
  v_lshlrev_b32 v168, 16, v138
  v_and_b32 v170, 0xffff0000, v138
  v_lshlrev_b32 v172, 16, v139
  v_and_b32 v174, 0xffff0000, v139
  v_lshlrev_b32 v161, 16, v140
  v_and_b32 v163, 0xffff0000, v140
  v_lshlrev_b32 v165, 16, v141
  v_and_b32 v167, 0xffff0000, v141
  v_lshlrev_b32 v169, 16, v142
  v_and_b32 v171, 0xffff0000, v142
  v_lshlrev_b32 v173, 16, v143
  v_and_b32 v175, 0xffff0000, v143
  v_lshlrev_b32 v64, 16, v96
  v_and_b32 v65, 0xffff0000, v96
  v_lshlrev_b32 v66, 16, v97
  v_and_b32 v67, 0xffff0000, v97
  v_lshlrev_b32 v68, 16, v98
  v_and_b32 v69, 0xffff0000, v98
  v_lshlrev_b32 v70, 16, v99
  v_and_b32 v71, 0xffff0000, v99
  v_mul_f32 v32, v64, v160
  v_mul_f32 v33, v65, v160
  v_mul_f32 v34, v66, v160
  v_mul_f32 v35, v67, v160
  v_mul_f32 v36, v68, v160
  v_mul_f32 v37, v69, v160
  v_mul_f32 v38, v70, v160
  v_mul_f32 v39, v71, v160
  v_mul_f32 v40, v64, v161
  v_mul_f32 v41, v65, v161
  v_mul_f32 v42, v66, v161
  v_mul_f32 v43, v67, v161
  v_mul_f32 v44, v68, v161
  v_mul_f32 v45, v69, v161
  v_mul_f32 v46, v70, v161
  v_mul_f32 v47, v71, v161
  v_lshlrev_b32 v64, 16, v100
  v_and_b32 v65, 0xffff0000, v100
  v_lshlrev_b32 v66, 16, v101
  v_and_b32 v67, 0xffff0000, v101
  v_lshlrev_b32 v68, 16, v102
  v_and_b32 v69, 0xffff0000, v102
  v_lshlrev_b32 v70, 16, v103
  v_and_b32 v71, 0xffff0000, v103
  v_fmac_f32 v32, v64, v162
  v_fmac_f32 v33, v65, v162
  v_fmac_f32 v34, v66, v162
  v_fmac_f32 v35, v67, v162
  v_fmac_f32 v36, v68, v162
  v_fmac_f32 v37, v69, v162
  v_fmac_f32 v38, v70, v162
  v_fmac_f32 v39, v71, v162
  v_fmac_f32 v40, v64, v163
  v_fmac_f32 v41, v65, v163
  v_fmac_f32 v42, v66, v163
  v_fmac_f32 v43, v67, v163
  v_fmac_f32 v44, v68, v163
  v_fmac_f32 v45, v69, v163
  v_fmac_f32 v46, v70, v163
  v_fmac_f32 v47, v71, v163
  v_lshlrev_b32 v64, 16, v104
  v_and_b32 v65, 0xffff0000, v104
  v_lshlrev_b32 v66, 16, v105
  v_and_b32 v67, 0xffff0000, v105
  v_lshlrev_b32 v68, 16, v106
  v_and_b32 v69, 0xffff0000, v106
  v_lshlrev_b32 v70, 16, v107
  v_and_b32 v71, 0xffff0000, v107
  v_fmac_f32 v32, v64, v164
  v_fmac_f32 v33, v65, v164
  v_fmac_f32 v34, v66, v164
  v_fmac_f32 v35, v67, v164
  v_fmac_f32 v36, v68, v164
  v_fmac_f32 v37, v69, v164
  v_fmac_f32 v38, v70, v164
  v_fmac_f32 v39, v71, v164
  v_fmac_f32 v40, v64, v165
  v_fmac_f32 v41, v65, v165
  v_fmac_f32 v42, v66, v165
  v_fmac_f32 v43, v67, v165
  v_fmac_f32 v44, v68, v165
  v_fmac_f32 v45, v69, v165
  v_fmac_f32 v46, v70, v165
  v_fmac_f32 v47, v71, v165
  v_lshlrev_b32 v64, 16, v108
  v_and_b32 v65, 0xffff0000, v108
  v_lshlrev_b32 v66, 16, v109
  v_and_b32 v67, 0xffff0000, v109
  v_lshlrev_b32 v68, 16, v110
  v_and_b32 v69, 0xffff0000, v110
  v_lshlrev_b32 v70, 16, v111
  v_and_b32 v71, 0xffff0000, v111
  v_fmac_f32 v32, v64, v166
  v_fmac_f32 v33, v65, v166
  v_fmac_f32 v34, v66, v166
  v_fmac_f32 v35, v67, v166
  v_fmac_f32 v36, v68, v166
  v_fmac_f32 v37, v69, v166
  v_fmac_f32 v38, v70, v166
  v_fmac_f32 v39, v71, v166
  v_fmac_f32 v40, v64, v167
  v_fmac_f32 v41, v65, v167
  v_fmac_f32 v42, v66, v167
  v_fmac_f32 v43, v67, v167
  v_fmac_f32 v44, v68, v167
  v_fmac_f32 v45, v69, v167
  v_fmac_f32 v46, v70, v167
  v_fmac_f32 v47, v71, v167
  v_lshlrev_b32 v64, 16, v112
  v_and_b32 v65, 0xffff0000, v112
  v_lshlrev_b32 v66, 16, v113
  v_and_b32 v67, 0xffff0000, v113
  v_lshlrev_b32 v68, 16, v114
  v_and_b32 v69, 0xffff0000, v114
  v_lshlrev_b32 v70, 16, v115
  v_and_b32 v71, 0xffff0000, v115
  v_fmac_f32 v32, v64, v168
  v_fmac_f32 v33, v65, v168
  v_fmac_f32 v34, v66, v168
  v_fmac_f32 v35, v67, v168
  v_fmac_f32 v36, v68, v168
  v_fmac_f32 v37, v69, v168
  v_fmac_f32 v38, v70, v168
  v_fmac_f32 v39, v71, v168
  v_fmac_f32 v40, v64, v169
  v_fmac_f32 v41, v65, v169
  v_fmac_f32 v42, v66, v169
  v_fmac_f32 v43, v67, v169
  v_fmac_f32 v44, v68, v169
  v_fmac_f32 v45, v69, v169
  v_fmac_f32 v46, v70, v169
  v_fmac_f32 v47, v71, v169
  v_lshlrev_b32 v64, 16, v116
  v_and_b32 v65, 0xffff0000, v116
  v_lshlrev_b32 v66, 16, v117
  v_and_b32 v67, 0xffff0000, v117
  v_lshlrev_b32 v68, 16, v118
  v_and_b32 v69, 0xffff0000, v118
  v_lshlrev_b32 v70, 16, v119
  v_and_b32 v71, 0xffff0000, v119
  v_fmac_f32 v32, v64, v170
  v_fmac_f32 v33, v65, v170
  v_fmac_f32 v34, v66, v170
  v_fmac_f32 v35, v67, v170
  v_fmac_f32 v36, v68, v170
  v_fmac_f32 v37, v69, v170
  v_fmac_f32 v38, v70, v170
  v_fmac_f32 v39, v71, v170
  v_fmac_f32 v40, v64, v171
  v_fmac_f32 v41, v65, v171
  v_fmac_f32 v42, v66, v171
  v_fmac_f32 v43, v67, v171
  v_fmac_f32 v44, v68, v171
  v_fmac_f32 v45, v69, v171
  v_fmac_f32 v46, v70, v171
  v_fmac_f32 v47, v71, v171
  v_lshlrev_b32 v64, 16, v120
  v_and_b32 v65, 0xffff0000, v120
  v_lshlrev_b32 v66, 16, v121
  v_and_b32 v67, 0xffff0000, v121
  v_lshlrev_b32 v68, 16, v122
  v_and_b32 v69, 0xffff0000, v122
  v_lshlrev_b32 v70, 16, v123
  v_and_b32 v71, 0xffff0000, v123
  v_fmac_f32 v32, v64, v172
  v_fmac_f32 v33, v65, v172
  v_fmac_f32 v34, v66, v172
  v_fmac_f32 v35, v67, v172
  v_fmac_f32 v36, v68, v172
  v_fmac_f32 v37, v69, v172
  v_fmac_f32 v38, v70, v172
  v_fmac_f32 v39, v71, v172
  v_fmac_f32 v40, v64, v173
  v_fmac_f32 v41, v65, v173
  v_fmac_f32 v42, v66, v173
  v_fmac_f32 v43, v67, v173
  v_fmac_f32 v44, v68, v173
  v_fmac_f32 v45, v69, v173
  v_fmac_f32 v46, v70, v173
  v_fmac_f32 v47, v71, v173
  v_lshlrev_b32 v64, 16, v124
  v_and_b32 v65, 0xffff0000, v124
  v_lshlrev_b32 v66, 16, v125
  v_and_b32 v67, 0xffff0000, v125
  v_lshlrev_b32 v68, 16, v126
  v_and_b32 v69, 0xffff0000, v126
  v_lshlrev_b32 v70, 16, v127
  v_and_b32 v71, 0xffff0000, v127
  v_fmac_f32 v32, v64, v174
  v_fmac_f32 v33, v65, v174
  v_fmac_f32 v34, v66, v174
  v_fmac_f32 v35, v67, v174
  v_fmac_f32 v36, v68, v174
  v_fmac_f32 v37, v69, v174
  v_fmac_f32 v38, v70, v174
  v_fmac_f32 v39, v71, v174
  v_fmac_f32 v40, v64, v175
  v_fmac_f32 v41, v65, v175
  v_fmac_f32 v42, v66, v175
  v_fmac_f32 v43, v67, v175
  v_fmac_f32 v44, v68, v175
  v_fmac_f32 v45, v69, v175
  v_fmac_f32 v46, v70, v175
  v_fmac_f32 v47, v71, v175
  s_waitcnt vmcnt(0)
  v_lshlrev_b32 v64, 16, v128
  v_and_b32 v65, 0xffff0000, v128
  v_lshlrev_b32 v66, 16, v129
  v_and_b32 v67, 0xffff0000, v129
  v_lshlrev_b32 v68, 16, v130
  v_and_b32 v69, 0xffff0000, v130
  v_lshlrev_b32 v70, 16, v131
  v_and_b32 v71, 0xffff0000, v131
  v_fmac_f32 v32, v64, v144
  v_fmac_f32 v33, v65, v144
  v_fmac_f32 v34, v66, v144
  v_fmac_f32 v35, v67, v144
  v_fmac_f32 v36, v68, v144
  v_fmac_f32 v37, v69, v144
  v_fmac_f32 v38, v70, v144
  v_fmac_f32 v39, v71, v144
  v_fmac_f32 v40, v64, v145
  v_fmac_f32 v41, v65, v145
  v_fmac_f32 v42, v66, v145
  v_fmac_f32 v43, v67, v145
  v_fmac_f32 v44, v68, v145
  v_fmac_f32 v45, v69, v145
  v_fmac_f32 v46, v70, v145
  v_fmac_f32 v47, v71, v145
  s_nop 1
  v_permlane32_swap_b32 v32, v40
  v_permlane32_swap_b32 v33, v41
  v_permlane32_swap_b32 v34, v42
  v_permlane32_swap_b32 v35, v43
  v_permlane32_swap_b32 v36, v44
  v_permlane32_swap_b32 v37, v45
  v_permlane32_swap_b32 v38, v46
  v_permlane32_swap_b32 v39, v47
  v_add_f32 v32, v32, v40
  v_add_f32 v33, v33, v41
  v_add_f32 v34, v34, v42
  v_add_f32 v35, v35, v43
  v_add_f32 v36, v36, v44
  v_add_f32 v37, v37, v45
  v_add_f32 v38, v38, v46
  v_add_f32 v39, v39, v47
  s_nop 1
  v_permlane16_swap_b32 v32, v36
  v_permlane16_swap_b32 v33, v37
  v_permlane16_swap_b32 v34, v38
  v_permlane16_swap_b32 v35, v39
  v_add_f32 v32, v32, v36
  v_add_f32 v33, v33, v37
  v_add_f32 v34, v34, v38
  v_add_f32 v35, v35, v39
  v_add_f32_dpp v32, v32, v32 row_ror:8 row_mask:0xf bank_mask:0xf
  v_add_f32_dpp v33, v33, v33 row_ror:8 row_mask:0xf bank_mask:0xf
  v_add_f32_dpp v34, v34, v34 row_ror:8 row_mask:0xf bank_mask:0xf
  v_add_f32_dpp v35, v35, v35 row_ror:8 row_mask:0xf bank_mask:0xf
  v_add_f32_dpp v32, v32, v32 row_ror:4 row_mask:0xf bank_mask:0xf
  v_add_f32_dpp v33, v33, v33 row_ror:4 row_mask:0xf bank_mask:0xf
  v_add_f32_dpp v34, v34, v34 row_ror:4 row_mask:0xf bank_mask:0xf
  v_add_f32_dpp v35, v35, v35 row_ror:4 row_mask:0xf bank_mask:0xf
  v_lshrrev_b32 v4, 5, v0
  v_lshlrev_b32 v4, 7, v4
  v_and_b32 v5, 3, v0
  v_lshl_add_u32 v4, v5, 5, v4
  v_and_b32 v5, 16, v0
  v_add_u32 v4, v4, v5
  v_lshl_add_u32 v4, s3, 8, v4
  v_mov_b32 v9, 1
  s_mov_b32 exec_lo, 0x000f000f
  s_mov_b32 exec_hi, 0x000f000f
  ds_write_b128 v4, v[32:35] offset:0
  s_waitcnt lgkmcnt(0)
  s_mov_b64 exec, 1
  ds_add_u32 v89, v9 offset:3076
  s_mov_b64 exec, -1
  s_cmp_eq_u32 s3, 0
  s_cbranch_scc0 L_notw0
  v_lshrrev_b32 v4, 3, v0
  v_lshlrev_b32 v4, 11, v4
  v_and_b32 v5, 7, v0
  v_lshl_add_u32 v4, v5, 4, v4
  s_lshl_b32 s6, s14, 12
  s_add_u32 s6, s6, 4096
  s_lshl_b32 s7, s101, 7
  s_add_u32 s7, s7, s6
  s_mul_i32 s100, s72, 0x9e3779b1
  s_add_u32 s100, s100, 0x7f4a7c15
  s_or_b32 s100, s100, 1
  s_mov_b32 s13, 3200000
L_waitp:
  ds_read_b32 v9, v89 offset:3076
  s_sub_u32 s13, s13, 1
  s_cbranch_scc1 L_waitp_done
  s_waitcnt lgkmcnt(0)
  v_cmp_ne_u32 vcc, 4, v9
  s_cbranch_vccnz L_waitp
L_waitp_done:
  s_mov_b64 exec, 0xffff
  ds_read_b128 v[32:35], v2 offset:0
  ds_read_b128 v[36:39], v2 offset:256
  ds_read_b128 v[40:43], v2 offset:512
  ds_read_b128 v[44:47], v2 offset:768
  v_mov_b32 v50, 0
  s_waitcnt lgkmcnt(0)
  v_add_f32 v32, v32, v40
  v_add_f32 v33, v33, v41
  v_add_f32 v34, v34, v42
  v_add_f32 v35, v35, v43
  v_add_f32 v36, v36, v44
  v_add_f32 v37, v37, v45
  v_add_f32 v38, v38, v46
  v_add_f32 v39, v39, v47
  v_add_f32 v32, v32, v36
  v_add_f32 v33, v33, v37
  v_add_f32 v34, v34, v38
  v_add_f32 v35, v35, v39
  v_cvt_pk_bf16_f32 v48, v32, v33
  v_cvt_pk_bf16_f32 v49, v34, v35
  v_bitop3_b32 v51, v48, v49, s100 bitop3:0x96
  buffer_store_dwordx4 v[48:51], v4, s[68:71], s7 offen sc1
  s_mov_b64 exec, -1
  s_lshr_b32 s7, s15, 3
  s_lshl_b32 s7, s7, 11
  s_add_u32 s7, s7, s6
  v_lshlrev_b32 v5, 5, v0
  s_sleep 50
  s_mov_b32 s13, 200000
L_poll0:
  buffer_load_dwordx4 v[32:35], v5, s[68:71], s7 offen offset:0 sc1
  buffer_load_dwordx4 v[36:39], v5, s[68:71], s7 offen offset:16 sc1
  s_sub_u32 s13, s13, 1
  s_cbranch_scc1 L_poll0_done
  s_waitcnt vmcnt(1)
  v_bitop3_b32 v8, v32, v33, v34 bitop3:0x96
  v_bitop3_b32 v8, v8, v35, s100 bitop3:0x96
  s_waitcnt vmcnt(0)
  v_bitop3_b32 v9, v36, v37, v38 bitop3:0x96
  v_bitop3_b32 v9, v9, v39, s100 bitop3:0x96
  v_or_b32 v8, v8, v9
  v_cmp_ne_u32 vcc, 0, v8
  s_and_b64 exec, exec, vcc
  s_cbranch_scc0 L_poll0_done
  s_sleep 20
  s_branch L_poll0
L_poll0_done:
  s_mov_b64 exec, -1
  s_waitcnt vmcnt(0)
  v_mov_b32 v34, v36
  v_mov_b32 v35, v37
  ds_write_b128 v2, v[32:35] offset:2048
  v_mov_b32 v9, 1
  s_waitcnt lgkmcnt(0)
  ds_write_b32 v89, v9 offset:3072
  s_branch L_prefetch0
L_notw0:
  s_cmp_eq_u32 s3, 2
  s_cbranch_scc0 L_prefetch0
  s_mov_b32 s80, s36
  s_mov_b32 s81, s37
  s_mov_b32 s82, 1152
  s_mov_b32 s83, 0x00020000
  v_and_b32 v4, 31, v0
  v_mul_u32_u24 v4, 36, v4
  v_lshrrev_b32 v6, 5, v0
  v_mul_u32_u24 v5, 1152, v6
  v_add_u32 v5, v5, v4
  v_lshlrev_b32 v12, 2, v6
  buffer_load_dwordx4 v[160:163], v5, s[76:79], 0 offen
  buffer_load_dwordx4 v[164:167], v5, s[76:79], 0 offen offset:16
  buffer_load_dword v168, v5, s[76:79], 0 offen offset:32
  buffer_load_dwordx4 v[172:175], v4, s[80:83], 0 offen
  buffer_load_dwordx4 v[176:179], v4, s[80:83], 0 offen offset:16
  buffer_load_dword v180, v4, s[80:83], 0 offen offset:32
  v_mov_b32 v10, 0
  s_waitcnt vmcnt(0)
  v_lshlrev_b32 v4, 16, v160
  v_and_b32 v5, 0xffff0000, v160
  v_lshlrev_b32 v6, 16, v172
  v_and_b32 v7, 0xffff0000, v172
  v_mul_f32 v4, v4, v6
  v_mul_f32 v5, v5, v7
  v_cvt_pk_bf16_f32 v4, v4, v5
  v_lshlrev_b32 v5, 16, v4
  v_and_b32 v4, 0xffff0000, v4
  v_add_f32 v10, v10, v5
  v_add_f32 v10, v10, v4
  v_lshlrev_b32 v4, 16, v161
  v_and_b32 v5, 0xffff0000, v161
  v_lshlrev_b32 v6, 16, v173
  v_and_b32 v7, 0xffff0000, v173
  v_mul_f32 v4, v4, v6
  v_mul_f32 v5, v5, v7
  v_cvt_pk_bf16_f32 v4, v4, v5
  v_lshlrev_b32 v5, 16, v4
  v_and_b32 v4, 0xffff0000, v4
  v_add_f32 v10, v10, v5
  v_add_f32 v10, v10, v4
  v_lshlrev_b32 v4, 16, v162
  v_and_b32 v5, 0xffff0000, v162
  v_lshlrev_b32 v6, 16, v174
  v_and_b32 v7, 0xffff0000, v174
  v_mul_f32 v4, v4, v6
  v_mul_f32 v5, v5, v7
  v_cvt_pk_bf16_f32 v4, v4, v5
  v_lshlrev_b32 v5, 16, v4
  v_and_b32 v4, 0xffff0000, v4
  v_add_f32 v10, v10, v5
  v_add_f32 v10, v10, v4
  v_lshlrev_b32 v4, 16, v163
  v_and_b32 v5, 0xffff0000, v163
  v_lshlrev_b32 v6, 16, v175
  v_and_b32 v7, 0xffff0000, v175
  v_mul_f32 v4, v4, v6
  v_mul_f32 v5, v5, v7
  v_cvt_pk_bf16_f32 v4, v4, v5
  v_lshlrev_b32 v5, 16, v4
  v_and_b32 v4, 0xffff0000, v4
  v_add_f32 v10, v10, v5
  v_add_f32 v10, v10, v4
  v_lshlrev_b32 v4, 16, v164
  v_and_b32 v5, 0xffff0000, v164
  v_lshlrev_b32 v6, 16, v176
  v_and_b32 v7, 0xffff0000, v176
  v_mul_f32 v4, v4, v6
  v_mul_f32 v5, v5, v7
  v_cvt_pk_bf16_f32 v4, v4, v5
  v_lshlrev_b32 v5, 16, v4
  v_and_b32 v4, 0xffff0000, v4
  v_add_f32 v10, v10, v5
  v_add_f32 v10, v10, v4
  v_lshlrev_b32 v4, 16, v165
  v_and_b32 v5, 0xffff0000, v165
  v_lshlrev_b32 v6, 16, v177
  v_and_b32 v7, 0xffff0000, v177
  v_mul_f32 v4, v4, v6
  v_mul_f32 v5, v5, v7
  v_cvt_pk_bf16_f32 v4, v4, v5
  v_lshlrev_b32 v5, 16, v4
  v_and_b32 v4, 0xffff0000, v4
  v_add_f32 v10, v10, v5
  v_add_f32 v10, v10, v4
  v_lshlrev_b32 v4, 16, v166
  v_and_b32 v5, 0xffff0000, v166
  v_lshlrev_b32 v6, 16, v178
  v_and_b32 v7, 0xffff0000, v178
  v_mul_f32 v4, v4, v6
  v_mul_f32 v5, v5, v7
  v_cvt_pk_bf16_f32 v4, v4, v5
  v_lshlrev_b32 v5, 16, v4
  v_and_b32 v4, 0xffff0000, v4
  v_add_f32 v10, v10, v5
  v_add_f32 v10, v10, v4
  v_lshlrev_b32 v4, 16, v167
  v_and_b32 v5, 0xffff0000, v167
  v_lshlrev_b32 v6, 16, v179
  v_and_b32 v7, 0xffff0000, v179
  v_mul_f32 v4, v4, v6
  v_mul_f32 v5, v5, v7
  v_cvt_pk_bf16_f32 v4, v4, v5
  v_lshlrev_b32 v5, 16, v4
  v_and_b32 v4, 0xffff0000, v4
  v_add_f32 v10, v10, v5
  v_add_f32 v10, v10, v4
  v_lshlrev_b32 v4, 16, v168
  v_and_b32 v5, 0xffff0000, v168
  v_lshlrev_b32 v6, 16, v180
  v_and_b32 v7, 0xffff0000, v180
  v_mul_f32 v4, v4, v6
  v_mul_f32 v5, v5, v7
  v_cvt_pk_bf16_f32 v4, v4, v5
  v_lshlrev_b32 v5, 16, v4
  v_and_b32 v4, 0xffff0000, v4
  v_add_f32 v10, v10, v5
  v_add_f32 v10, v10, v4
  s_nop 1
  v_add_f32_dpp v10, v10, v10 row_ror:8 row_mask:0xf bank_mask:0xf
  s_nop 1
  v_add_f32_dpp v10, v10, v10 row_ror:4 row_mask:0xf bank_mask:0xf
  s_nop 1
  v_add_f32_dpp v10, v10, v10 row_ror:2 row_mask:0xf bank_mask:0xf
  s_nop 1
  v_add_f32_dpp v10, v10, v10 row_ror:1 row_mask:0xf bank_mask:0xf
  v_mov_b32 v11, v10
  s_nop 1
  v_permlane16_swap_b32 v10, v11
  v_add_f32 v10, v10, v11
  v_cvt_pk_bf16_f32 v10, v10, v10
  v_and_b32 v10, 0xffff0000, v10
  v_mul_f32 v10, 0xbfb8aa3b, v10
  v_exp_f32 v10, v10
  s_nop 0
  v_add_f32 v10, 1.0, v10
  v_rcp_f32 v10, v10
  s_nop 0
  v_cvt_pk_bf16_f32 v10, v10, v10
  v_and_b32 v10, 0xffff0000, v10
  v_sub_f32 v11, 1.0, v10
  v_cvt_pk_bf16_f32 v11, v11, v11
  v_and_b32 v11, 0xffff0000, v11
  s_cmp_ge_u32 s15, 8
  s_cselect_b64 vcc, -1, 0
  s_nop 1
  v_cndmask_b32 v10, v10, v11, vcc
  s_mov_b32 exec_lo, 1
  s_mov_b32 exec_hi, 1
  ds_write_b32 v12, v10 offset:3648
  s_mov_b64 exec, -1
L_prefetch0:
  s_setprio 2
  s_mov_b64 exec, 1
  v_mov_b32 v93, 1
  ds_add_rtn_u32 v93, v89, v93 offset:3080
  s_mov_b64 exec, -1
  s_waitcnt lgkmcnt(0)
  v_readfirstlane_b32 s18, v93
  s_and_b32 s18, s18, 0xffff
  s_mov_b32 s13, 3200000
L_spin_a:
  ds_read_b64 v[10:11], v89 offset:3088
  s_sub_u32 s13, s13, 1
  s_cbranch_scc1 L_spin_a_done
  s_waitcnt lgkmcnt(0)
  v_readfirstlane_b32 s7, v11
  s_cmp_ge_u32 s7, s18
  s_cbranch_scc1 L_spin_a_done
  s_sleep 1
  s_branch L_spin_a
L_spin_a_done:
  s_waitcnt lgkmcnt(0)
  s_xor_b32 s9, s4, 32768
  buffer_load_dwordx4 v[96:99], v1, s[44:47], s4 offen offset:0 nt
  buffer_load_dwordx4 v[100:103], v1, s[44:47], s4 offen offset:64 nt
  buffer_load_dwordx4 v[104:107], v1, s[44:47], s4 offen offset:128 nt
  buffer_load_dwordx4 v[108:111], v1, s[44:47], s4 offen offset:192 nt
  buffer_load_dwordx4 v[112:115], v1, s[44:47], s9 offen offset:0 nt
  buffer_load_dwordx4 v[116:119], v1, s[44:47], s9 offen offset:64 nt
  buffer_load_dwordx4 v[120:123], v1, s[44:47], s9 offen offset:128 nt
  buffer_load_dwordx4 v[124:127], v1, s[44:47], s9 offen offset:192 nt
  buffer_load_dwordx4 v[128:131], v2, s[48:51], s4 offen offset:0 nt
  buffer_load_dwordx4 v[132:135], v2, s[48:51], s4 offen offset:1024 nt
  buffer_load_dwordx4 v[136:139], v2, s[48:51], s4 offen offset:2048 nt
  buffer_load_dwordx4 v[140:143], v2, s[48:51], s4 offen offset:3072 nt
  s_mov_b64 exec, 1
  v_mov_b32 v90, 1
  ds_add_u32 v89, v90 offset:3092
  s_mov_b64 exec, -1
  buffer_load_dwordx4 v[144:147], v2, s[48:51], s9 offen offset:0 nt
  buffer_load_dwordx4 v[148:151], v2, s[48:51], s9 offen offset:1024 nt
  buffer_load_dwordx4 v[152:155], v2, s[48:51], s9 offen offset:2048 nt
  buffer_load_dwordx4 v[156:159], v2, s[48:51], s9 offen offset:3072 nt
L_afterA:
  s_mov_b64 exec, 1
  v_mov_b32 v93, 65537
  ds_add_rtn_u32 v93, v89, v93 offset:3080
  s_mov_b64 exec, -1
  s_mov_b32 s16, 1
  s_mov_b32 s24, 0
  s_mov_b32 s26, 0x01010101
  s_mov_b32 s27, 0x01010101
  s_mov_b32 s28, s73
  s_lshr_b32 s8, s2, 3
  s_bfe_u32 s7, s8, 65536
  s_lshl_b32 s7, s7, 12
  s_xor_b32 s28, s28, s7
  s_bfe_u32 s7, s8, 196609
  s_lshl_b32 s7, s7, 12
  s_xor_b32 s28, s28, s7
  v_mov_b32 v94, 0
  s_branch L_slot
L_afterfirst:
  s_load_dword s72, s[68:69], 0
  s_mov_b32 s13, 3200000
L_waitq:
  ds_read_b32 v9, v89 offset:3072
  s_sub_u32 s13, s13, 1
  s_cbranch_scc1 L_waitq_done
  s_waitcnt lgkmcnt(0)
  v_cmp_eq_u32 vcc, 1, v9
  s_cbranch_vccnz L_waitq_done
  s_sleep 2
  s_branch L_waitq
L_waitq_done:
  s_waitcnt lgkmcnt(0)
  s_mul_i32 s100, s72, 0x9e3779b1
  s_add_u32 s100, s100, 0x7f4a7c15
  s_or_b32 s100, s100, 1
  v_bfe_u32 v6, v0, 3, 1
  v_lshrrev_b32 v7, 4, v0
  v_lshlrev_b32 v8, 8, v6
  v_lshl_add_u32 v8, v7, 4, v8
  ds_read_b128 v[16:19], v8 offset:2048
  ds_read_b128 v[20:23], v8 offset:2112
  ds_read_b128 v[24:27], v8 offset:2176
  ds_read_b128 v[28:31], v8 offset:2240
  v_mov_b32 v32, 0
  v_mov_b32 v33, 0
  v_mov_b32 v34, 0
  v_mov_b32 v35, 0
  v_mov_b32 v36, 0
  v_mov_b32 v37, 0
  v_mov_b32 v38, 0
  v_mov_b32 v39, 0
  v_mov_b32 v40, 0
  v_mov_b32 v41, 0
  v_mov_b32 v42, 0
  v_mov_b32 v43, 0
  v_mov_b32 v44, 0
  v_mov_b32 v45, 0
  v_mov_b32 v46, 0
  v_mov_b32 v47, 0
  v_mov_b32 v48, 0
  v_mov_b32 v49, 0
  v_mov_b32 v50, 0
  v_mov_b32 v51, 0
  v_mov_b32 v52, 0
  v_mov_b32 v53, 0
  v_mov_b32 v54, 0
  v_mov_b32 v55, 0
  v_mov_b32 v56, 0
  v_mov_b32 v57, 0
  v_mov_b32 v58, 0
  v_mov_b32 v59, 0
  v_mov_b32 v60, 0
  v_mov_b32 v61, 0
  v_mov_b32 v62, 0
  v_mov_b32 v63, 0
  v_mov_b32 v224, 0
  v_mov_b32 v225, 0
  v_mov_b32 v226, 0
  v_mov_b32 v227, 0
  v_mov_b32 v84, 0xff167699
  v_mov_b32 v86, 0
  v_mov_b32 v85, 0
  v_add_u32 v91, 5120, v2
  v_mov_b32 v87, 0
  v_lshlrev_b32 v92, 3, v6
  v_add_u32 v92, 3712, v92
  v_lshl_add_u32 v6, v6, 2, v7
  v_mul_u32_u24 v6, 2176, v6
  v_and_b32 v7, 7, v0
  v_lshl_add_u32 v14, v7, 4, v6
  s_mul_i32 s6, s14, 34816
  s_lshl_b32 s7, s101, 7
  s_add_u32 s6, s6, s7
  s_add_u32 s30, s6, 131072
  s_mov_b32 s75, 0
  s_waitcnt lgkmcnt(0)
  s_waitcnt vmcnt(28)
  v_mfma_f32_16x16x32_bf16 v[64:67], v[96:99], v[16:19], 0
  v_mfma_f32_16x16x32_bf16 v[64:67], v[100:103], v[20:23], v[64:67]
  v_mfma_f32_16x16x32_bf16 v[64:67], v[104:107], v[24:27], v[64:67]
  v_mfma_f32_16x16x32_bf16 v[64:67], v[108:111], v[28:31], v[64:67]
  s_waitcnt vmcnt(24)
  v_mfma_f32_16x16x32_bf16 v[68:71], v[112:115], v[16:19], 0
  v_mfma_f32_16x16x32_bf16 v[68:71], v[116:119], v[20:23], v[68:71]
  v_mfma_f32_16x16x32_bf16 v[68:71], v[120:123], v[24:27], v[68:71]
  v_mfma_f32_16x16x32_bf16 v[68:71], v[124:127], v[28:31], v[68:71]
  s_nop 2
  v_cvt_pk_bf16_f32 v72, v64, v65
  v_cvt_pk_bf16_f32 v73, v66, v67
  v_lshlrev_b32 v64, 16, v72
  v_and_b32 v65, 0xffff0000, v72
  v_lshlrev_b32 v66, 16, v73
  v_and_b32 v67, 0xffff0000, v73
  v_mul_f32 v64, s25, v64
  v_mul_f32 v65, s25, v65
  v_mul_f32 v66, s25, v66
  v_mul_f32 v67, s25, v67
  v_cvt_pk_bf16_f32 v72, v64, v65
  v_cvt_pk_bf16_f32 v73, v66, v67
  v_lshlrev_b32 v64, 16, v72
  v_and_b32 v65, 0xffff0000, v72
  v_lshlrev_b32 v66, 16, v73
  v_and_b32 v67, 0xffff0000, v73
  v_max3_f32 v3, v64, v65, v84
  v_max3_f32 v3, v66, v67, v3
  v_cvt_pk_bf16_f32 v74, v68, v69
  v_cvt_pk_bf16_f32 v75, v70, v71
  v_lshlrev_b32 v68, 16, v74
  v_and_b32 v69, 0xffff0000, v74
  v_lshlrev_b32 v70, 16, v75
  v_and_b32 v71, 0xffff0000, v75
  v_mul_f32 v68, s25, v68
  v_mul_f32 v69, s25, v69
  v_mul_f32 v70, s25, v70
  v_mul_f32 v71, s25, v71
  v_cvt_pk_bf16_f32 v74, v68, v69
  v_cvt_pk_bf16_f32 v75, v70, v71
  v_lshlrev_b32 v68, 16, v74
  v_and_b32 v69, 0xffff0000, v74
  v_lshlrev_b32 v70, 16, v75
  v_and_b32 v71, 0xffff0000, v75
  v_max3_f32 v3, v68, v69, v3
  v_max3_f32 v3, v70, v71, v3
  v_mul_f32 v5, s10, v84
  v_mov_b32 v4, v3
  s_nop 1
  v_permlane32_swap_b32 v3, v4
  v_max_f32 v3, v3, v4
  v_mov_b32 v4, v3
  s_nop 1
  v_permlane16_swap_b32 v3, v4
  v_max_f32 v84, v3, v4
  v_mul_f32 v6, s10, v84
  v_sub_f32 v5, v5, v6
  v_fma_f32 v64, v64, s10, -v6
  v_fma_f32 v65, v65, s10, -v6
  v_fma_f32 v66, v66, s10, -v6
  v_fma_f32 v67, v67, s10, -v6
  v_fma_f32 v68, v68, s10, -v6
  v_fma_f32 v69, v69, s10, -v6
  v_fma_f32 v70, v70, s10, -v6
  v_fma_f32 v71, v71, s10, -v6
  v_exp_f32 v5, v5
  v_exp_f32 v64, v64
  v_exp_f32 v65, v65
  v_exp_f32 v66, v66
  v_exp_f32 v67, v67
  v_exp_f32 v68, v68
  v_exp_f32 v69, v69
  v_exp_f32 v70, v70
  v_exp_f32 v71, v71
  v_mul_f32 v224, v224, v5
  v_mul_f32 v225, v225, v5
  v_mul_f32 v226, v226, v5
  v_mul_f32 v227, v227, v5
  s_lshl_b64 exec, s[26:27], 0
  v_cvt_pk_bf16_f32 v32, v64, v65
  v_cvt_pk_bf16_f32 v33, v66, v67
  v_cvt_pk_bf16_f32 v34, v68, v69
  v_cvt_pk_bf16_f32 v35, v70, v71
  s_lshl_b64 exec, s[26:27], 1
  v_cvt_pk_bf16_f32 v36, v64, v65
  v_cvt_pk_bf16_f32 v37, v66, v67
  v_cvt_pk_bf16_f32 v38, v68, v69
  v_cvt_pk_bf16_f32 v39, v70, v71
  s_lshl_b64 exec, s[26:27], 2
  v_cvt_pk_bf16_f32 v40, v64, v65
  v_cvt_pk_bf16_f32 v41, v66, v67
  v_cvt_pk_bf16_f32 v42, v68, v69
  v_cvt_pk_bf16_f32 v43, v70, v71
  s_lshl_b64 exec, s[26:27], 3
  v_cvt_pk_bf16_f32 v44, v64, v65
  v_cvt_pk_bf16_f32 v45, v66, v67
  v_cvt_pk_bf16_f32 v46, v68, v69
  v_cvt_pk_bf16_f32 v47, v70, v71
  s_lshl_b64 exec, s[26:27], 4
  v_cvt_pk_bf16_f32 v48, v64, v65
  v_cvt_pk_bf16_f32 v49, v66, v67
  v_cvt_pk_bf16_f32 v50, v68, v69
  v_cvt_pk_bf16_f32 v51, v70, v71
  s_lshl_b64 exec, s[26:27], 5
  v_cvt_pk_bf16_f32 v52, v64, v65
  v_cvt_pk_bf16_f32 v53, v66, v67
  v_cvt_pk_bf16_f32 v54, v68, v69
  v_cvt_pk_bf16_f32 v55, v70, v71
  s_lshl_b64 exec, s[26:27], 6
  v_cvt_pk_bf16_f32 v56, v64, v65
  v_cvt_pk_bf16_f32 v57, v66, v67
  v_cvt_pk_bf16_f32 v58, v68, v69
  v_cvt_pk_bf16_f32 v59, v70, v71
  s_lshl_b64 exec, s[26:27], 7
  v_cvt_pk_bf16_f32 v60, v64, v65
  v_cvt_pk_bf16_f32 v61, v66, v67
  v_cvt_pk_bf16_f32 v62, v68, v69
  v_cvt_pk_bf16_f32 v63, v70, v71
  s_mov_b64 exec, -1
  s_waitcnt vmcnt(16)
  v_perm_b32 v76, v132, v128, s11
  v_perm_b32 v77, v140, v136, s11
  v_perm_b32 v78, v148, v144, s11
  v_perm_b32 v79, v156, v152, s11
  v_perm_b32 v80, v132, v128, s12
  v_perm_b32 v81, v140, v136, s12
  v_perm_b32 v82, v148, v144, s12
  v_perm_b32 v83, v156, v152, s12
  v_mfma_f32_16x16x32_bf16 v[224:227], v[76:79], v[32:35], v[224:227]
  v_perm_b32 v76, v133, v129, s11
  v_perm_b32 v77, v141, v137, s11
  v_perm_b32 v78, v149, v145, s11
  v_perm_b32 v79, v157, v153, s11
  v_mfma_f32_16x16x32_bf16 v[224:227], v[80:83], v[36:39], v[224:227]
  v_perm_b32 v80, v133, v129, s12
  v_perm_b32 v81, v141, v137, s12
  v_perm_b32 v82, v149, v145, s12
  v_perm_b32 v83, v157, v153, s12
  v_mfma_f32_16x16x32_bf16 v[224:227], v[76:79], v[40:43], v[224:227]
  v_perm_b32 v76, v134, v130, s11
  v_perm_b32 v77, v142, v138, s11
  v_perm_b32 v78, v150, v146, s11
  v_perm_b32 v79, v158, v154, s11
  v_mfma_f32_16x16x32_bf16 v[224:227], v[80:83], v[44:47], v[224:227]
  v_perm_b32 v80, v134, v130, s12
  v_perm_b32 v81, v142, v138, s12
  v_perm_b32 v82, v150, v146, s12
  v_perm_b32 v83, v158, v154, s12
  v_mfma_f32_16x16x32_bf16 v[224:227], v[76:79], v[48:51], v[224:227]
  v_perm_b32 v76, v135, v131, s11
  v_perm_b32 v77, v143, v139, s11
  v_perm_b32 v78, v151, v147, s11
  v_perm_b32 v79, v159, v155, s11
  v_mfma_f32_16x16x32_bf16 v[224:227], v[80:83], v[52:55], v[224:227]
  v_perm_b32 v80, v135, v131, s12
  v_perm_b32 v81, v143, v139, s12
  v_perm_b32 v82, v151, v147, s12
  v_perm_b32 v83, v159, v155, s12
  v_mfma_f32_16x16x32_bf16 v[224:227], v[76:79], v[56:59], v[224:227]
  s_nop 1
  v_mfma_f32_16x16x32_bf16 v[224:227], v[80:83], v[60:63], v[224:227]
  v_add_f32 v3, v64, v65
  v_add_f32 v4, v66, v67
  v_fma_f32 v86, v86, v5, v3
  v_add_f32 v5, v68, v69
  v_add_f32 v6, v70, v71
  v_add_f32 v4, v4, v5
  v_add_f32 v86, v86, v6
  v_add_f32 v86, v86, v4
  v_mov_b32 v4, v86
  v_mov_b32 v5, v86
  s_nop 1
  v_permlane32_swap_b32 v4, v5
  v_add_f32 v4, v4, v5
  v_mov_b32 v5, v4
  s_nop 1
  v_permlane16_swap_b32 v4, v5
  v_add_f32 v85, v4, v5
  s_branch L_flush
L_retA:
  v_bfe_u32 v6, v0, 3, 1
  v_lshrrev_b32 v7, 4, v0
  v_lshlrev_b32 v8, 8, v6
  v_lshl_add_u32 v8, v7, 4, v8
  ds_read_b128 v[16:19], v8 offset:2560
  ds_read_b128 v[20:23], v8 offset:2624
  ds_read_b128 v[24:27], v8 offset:2688
  ds_read_b128 v[28:31], v8 offset:2752
  v_mov_b32 v224, 0
  v_mov_b32 v225, 0
  v_mov_b32 v226, 0
  v_mov_b32 v227, 0
  v_mov_b32 v84, 0xff167699
  v_mov_b32 v86, 0
  v_mov_b32 v85, 0
  v_add_u32 v91, 13312, v2
  v_mov_b32 v87, 4
  v_lshlrev_b32 v92, 3, v6
  v_add_u32 v92, 3840, v92
  s_mul_i32 s6, s14, 34816
  s_lshl_b32 s7, s101, 7
  s_add_u32 s6, s6, s7
  s_add_u32 s30, s6, 148480
  s_mov_b32 s75, 1
  s_waitcnt lgkmcnt(0)
  s_cmp_eq_u32 s16, 2
  s_cbranch_scc0 L_loop
  s_mov_b32 s16, 0
  s_branch L_exit
L_loop:
  s_waitcnt vmcnt(12)
  v_mfma_f32_16x16x32_bf16 v[64:67], v[160:163], v[16:19], 0
  v_mfma_f32_16x16x32_bf16 v[64:67], v[164:167], v[20:23], v[64:67]
  v_mfma_f32_16x16x32_bf16 v[64:67], v[168:171], v[24:27], v[64:67]
  v_mfma_f32_16x16x32_bf16 v[64:67], v[172:175], v[28:31], v[64:67]
  s_waitcnt vmcnt(8)
  v_mfma_f32_16x16x32_bf16 v[68:71], v[176:179], v[16:19], 0
  v_mfma_f32_16x16x32_bf16 v[68:71], v[180:183], v[20:23], v[68:71]
  v_mfma_f32_16x16x32_bf16 v[68:71], v[184:187], v[24:27], v[68:71]
  v_mfma_f32_16x16x32_bf16 v[68:71], v[188:191], v[28:31], v[68:71]
  s_nop 2
  v_cvt_pk_bf16_f32 v72, v64, v65
  v_cvt_pk_bf16_f32 v73, v66, v67
  v_lshlrev_b32 v64, 16, v72
  v_and_b32 v65, 0xffff0000, v72
  v_lshlrev_b32 v66, 16, v73
  v_and_b32 v67, 0xffff0000, v73
  v_mul_f32 v64, s25, v64
  v_mul_f32 v65, s25, v65
  v_mul_f32 v66, s25, v66
  v_mul_f32 v67, s25, v67
  v_cvt_pk_bf16_f32 v72, v64, v65
  v_cvt_pk_bf16_f32 v73, v66, v67
  v_lshlrev_b32 v64, 16, v72
  v_and_b32 v65, 0xffff0000, v72
  v_lshlrev_b32 v66, 16, v73
  v_and_b32 v67, 0xffff0000, v73
  v_max3_f32 v3, v64, v65, v84
  v_max3_f32 v3, v66, v67, v3
  v_cvt_pk_bf16_f32 v74, v68, v69
  v_cvt_pk_bf16_f32 v75, v70, v71
  v_lshlrev_b32 v68, 16, v74
  v_and_b32 v69, 0xffff0000, v74
  v_lshlrev_b32 v70, 16, v75
  v_and_b32 v71, 0xffff0000, v75
  v_mul_f32 v68, s25, v68
  v_mul_f32 v69, s25, v69
  v_mul_f32 v70, s25, v70
  v_mul_f32 v71, s25, v71
  v_cvt_pk_bf16_f32 v74, v68, v69
  v_cvt_pk_bf16_f32 v75, v70, v71
  v_lshlrev_b32 v68, 16, v74
  v_and_b32 v69, 0xffff0000, v74
  v_lshlrev_b32 v70, 16, v75
  v_and_b32 v71, 0xffff0000, v75
  v_max3_f32 v3, v68, v69, v3
  v_max3_f32 v3, v70, v71, v3
  v_mul_f32 v5, s10, v84
  v_mov_b32 v4, v3
  s_nop 1
  v_permlane32_swap_b32 v3, v4
  v_max_f32 v3, v3, v4
  v_mov_b32 v4, v3
  s_nop 1
  v_permlane16_swap_b32 v3, v4
  v_max_f32 v84, v3, v4
  v_mul_f32 v6, s10, v84
  v_sub_f32 v5, v5, v6
  v_fma_f32 v64, v64, s10, -v6
  v_fma_f32 v65, v65, s10, -v6
  v_fma_f32 v66, v66, s10, -v6
  v_fma_f32 v67, v67, s10, -v6
  v_fma_f32 v68, v68, s10, -v6
  v_fma_f32 v69, v69, s10, -v6
  v_fma_f32 v70, v70, s10, -v6
  v_fma_f32 v71, v71, s10, -v6
  v_exp_f32 v5, v5
  v_exp_f32 v64, v64
  v_exp_f32 v65, v65
  v_exp_f32 v66, v66
  v_exp_f32 v67, v67
  v_exp_f32 v68, v68
  v_exp_f32 v69, v69
  v_exp_f32 v70, v70
  v_exp_f32 v71, v71
  v_mul_f32 v224, v224, v5
  v_mul_f32 v225, v225, v5
  v_mul_f32 v226, v226, v5
  v_mul_f32 v227, v227, v5
  s_lshl_b64 exec, s[26:27], 0
  v_cvt_pk_bf16_f32 v32, v64, v65
  v_cvt_pk_bf16_f32 v33, v66, v67
  v_cvt_pk_bf16_f32 v34, v68, v69
  v_cvt_pk_bf16_f32 v35, v70, v71
  s_lshl_b64 exec, s[26:27], 1
  v_cvt_pk_bf16_f32 v36, v64, v65
  v_cvt_pk_bf16_f32 v37, v66, v67
  v_cvt_pk_bf16_f32 v38, v68, v69
  v_cvt_pk_bf16_f32 v39, v70, v71
  s_lshl_b64 exec, s[26:27], 2
  v_cvt_pk_bf16_f32 v40, v64, v65
  v_cvt_pk_bf16_f32 v41, v66, v67
  v_cvt_pk_bf16_f32 v42, v68, v69
  v_cvt_pk_bf16_f32 v43, v70, v71
  s_lshl_b64 exec, s[26:27], 3
  v_cvt_pk_bf16_f32 v44, v64, v65
  v_cvt_pk_bf16_f32 v45, v66, v67
  v_cvt_pk_bf16_f32 v46, v68, v69
  v_cvt_pk_bf16_f32 v47, v70, v71
  s_lshl_b64 exec, s[26:27], 4
  v_cvt_pk_bf16_f32 v48, v64, v65
  v_cvt_pk_bf16_f32 v49, v66, v67
  v_cvt_pk_bf16_f32 v50, v68, v69
  v_cvt_pk_bf16_f32 v51, v70, v71
  s_lshl_b64 exec, s[26:27], 5
  v_cvt_pk_bf16_f32 v52, v64, v65
  v_cvt_pk_bf16_f32 v53, v66, v67
  v_cvt_pk_bf16_f32 v54, v68, v69
  v_cvt_pk_bf16_f32 v55, v70, v71
  s_lshl_b64 exec, s[26:27], 6
  v_cvt_pk_bf16_f32 v56, v64, v65
  v_cvt_pk_bf16_f32 v57, v66, v67
  v_cvt_pk_bf16_f32 v58, v68, v69
  v_cvt_pk_bf16_f32 v59, v70, v71
  s_lshl_b64 exec, s[26:27], 7
  v_cvt_pk_bf16_f32 v60, v64, v65
  v_cvt_pk_bf16_f32 v61, v66, v67
  v_cvt_pk_bf16_f32 v62, v68, v69
  v_cvt_pk_bf16_f32 v63, v70, v71
  s_mov_b64 exec, -1
  s_waitcnt vmcnt(0)
  s_mov_b64 exec, 1
  v_mov_b32 v93, 65537
  ds_add_rtn_u32 v93, v89, v93 offset:3080
  s_mov_b64 exec, -1
  ds_read_b32 v94, v89 offset:3088
  ds_read_b32 v95, v87 offset:3096
  ds_read_b64 v[228:229], v92 offset:112
  ds_read_b128 v[232:235], v91 offset:7168
  v_perm_b32 v76, v196, v192, s11
  v_perm_b32 v77, v204, v200, s11
  v_perm_b32 v78, v212, v208, s11
  v_perm_b32 v79, v220, v216, s11
  v_perm_b32 v80, v196, v192, s12
  v_perm_b32 v81, v204, v200, s12
  v_perm_b32 v82, v212, v208, s12
  v_perm_b32 v83, v220, v216, s12
  v_mfma_f32_16x16x32_bf16 v[224:227], v[76:79], v[32:35], v[224:227]
  v_perm_b32 v76, v197, v193, s11
  v_perm_b32 v77, v205, v201, s11
  v_perm_b32 v78, v213, v209, s11
  v_perm_b32 v79, v221, v217, s11
  v_mfma_f32_16x16x32_bf16 v[224:227], v[80:83], v[36:39], v[224:227]
  v_perm_b32 v80, v197, v193, s12
  v_perm_b32 v81, v205, v201, s12
  v_perm_b32 v82, v213, v209, s12
  v_perm_b32 v83, v221, v217, s12
  v_mfma_f32_16x16x32_bf16 v[224:227], v[76:79], v[40:43], v[224:227]
  v_perm_b32 v76, v198, v194, s11
  v_perm_b32 v77, v206, v202, s11
  v_perm_b32 v78, v214, v210, s11
  v_perm_b32 v79, v222, v218, s11
  v_mfma_f32_16x16x32_bf16 v[224:227], v[80:83], v[44:47], v[224:227]
  v_perm_b32 v80, v198, v194, s12
  v_perm_b32 v81, v206, v202, s12
  v_perm_b32 v82, v214, v210, s12
  v_perm_b32 v83, v222, v218, s12
  v_mfma_f32_16x16x32_bf16 v[224:227], v[76:79], v[48:51], v[224:227]
  v_perm_b32 v76, v199, v195, s11
  v_perm_b32 v77, v207, v203, s11
  v_perm_b32 v78, v215, v211, s11
  v_perm_b32 v79, v223, v219, s11
  v_mfma_f32_16x16x32_bf16 v[224:227], v[80:83], v[52:55], v[224:227]
  v_perm_b32 v80, v199, v195, s12
  v_perm_b32 v81, v207, v203, s12
  v_perm_b32 v82, v215, v211, s12
  v_perm_b32 v83, v223, v219, s12
  v_mfma_f32_16x16x32_bf16 v[224:227], v[76:79], v[56:59], v[224:227]
  s_nop 1
  v_mfma_f32_16x16x32_bf16 v[224:227], v[80:83], v[60:63], v[224:227]
  s_waitcnt lgkmcnt(0)
  v_readfirstlane_b32 s17, v95
  v_add_f32 v3, v64, v65
  v_add_f32 v4, v66, v67
  v_fma_f32 v86, v86, v5, v3
  v_add_f32 v5, v68, v69
  v_add_f32 v6, v70, v71
  v_add_f32 v4, v4, v5
  v_add_f32 v86, v86, v6
  v_add_f32 v86, v86, v4
  v_mov_b32 v4, v86
  v_mov_b32 v5, v86
  s_nop 1
  v_permlane32_swap_b32 v4, v5
  v_add_f32 v4, v4, v5
  v_mov_b32 v5, v4
  s_nop 1
  v_permlane16_swap_b32 v4, v5
  v_add_f32 v85, v4, v5
  s_cmp_eq_u32 s17, 7
  s_cbranch_scc1 L_merge
L_slot:
  s_waitcnt lgkmcnt(0)
  v_readfirstlane_b32 s6, v94
  v_readfirstlane_b32 s7, v93
  s_and_b32 s18, s7, 0xffff
  s_cmp_lt_u32 s7, 1769472
  s_cbranch_scc0 L_dyn
  s_and_b32 s6, s7, 0x1f0000
  s_or_b32 s8, s5, s6
  s_and_b32 s6, s7, 0x10000
  s_lshr_b32 s6, s6, 3
  s_xor_b32 s8, s8, s6
  s_branch L_issue
L_dyn:
  s_cmp_eq_u32 s24, 0
  s_cbranch_scc1 L_noap2
  buffer_store_dwordx4 v[236:239], v14, s[68:71], s24 offen sc1
  s_mov_b32 s24, 0
L_noap2:
  s_cmp_lg_u32 s6, 0
  s_cbranch_scc1 L_exit_pass
  s_mov_b32 s13, 3200000
L_spin_la:
  ds_read_b64 v[10:11], v89 offset:3088
  s_sub_u32 s13, s13, 1
  s_cbranch_scc1 L_spin_la_done
  s_waitcnt lgkmcnt(0)
  v_readfirstlane_b32 s6, v10
  v_readfirstlane_b32 s7, v11
  s_cmp_lg_u32 s6, 0
  s_cbranch_scc1 L_exit_pass
  s_cmp_ge_u32 s7, s18
  s_cbranch_scc1 L_spin_la_done
  s_sleep 1
  s_branch L_spin_la
L_spin_la_done:
  s_waitcnt lgkmcnt(0)
  s_mov_b32 s6, 1
  s_atomic_add s6, s[68:69], s74 glc
  s_waitcnt lgkmcnt(0)
  s_cmp_ge_u32 s6, 256
  s_cbranch_scc1 L_exit_pass
  s_mov_b32 s8, s28
  s_bfe_u32 s7, s6, 196608
  s_lshl_b32 s7, s7, 12
  s_xor_b32 s8, s8, s7
  s_bfe_u32 s7, s6, 327683
  s_lshl_b32 s7, s7, 16
  s_xor_b32 s8, s8, s7
  s_branch L_issue_go
L_issue:
  s_mov_b32 s13, 3200000
L_spin_turn:
  ds_read_b64 v[10:11], v89 offset:3088
  s_sub_u32 s13, s13, 1
  s_cbranch_scc1 L_spin_turn_done
  s_waitcnt lgkmcnt(0)
  v_readfirstlane_b32 s7, v11
  s_cmp_ge_u32 s7, s18
  s_cbranch_scc1 L_spin_turn_done
  s_sleep 1
  s_branch L_spin_turn
L_spin_turn_done:
  s_waitcnt lgkmcnt(0)
L_issue_go:
  s_setprio 1
  s_xor_b32 s9, s8, 32768
  buffer_load_dwordx4 v[160:163], v1, s[52:55], s8 offen offset:0 nt
  buffer_load_dwordx4 v[164:167], v1, s[52:55], s8 offen offset:64 nt
  buffer_load_dwordx4 v[168:171], v1, s[52:55], s8 offen offset:128 nt
  buffer_load_dwordx4 v[172:175], v1, s[52:55], s8 offen offset:192 nt
  buffer_load_dwordx4 v[176:179], v1, s[52:55], s9 offen offset:0 nt
  buffer_load_dwordx4 v[180:183], v1, s[52:55], s9 offen offset:64 nt
  buffer_load_dwordx4 v[184:187], v1, s[52:55], s9 offen offset:128 nt
  buffer_load_dwordx4 v[188:191], v1, s[52:55], s9 offen offset:192 nt
  buffer_load_dwordx4 v[192:195], v2, s[56:59], s8 offen offset:0 nt
  buffer_load_dwordx4 v[196:199], v2, s[56:59], s8 offen offset:1024 nt
  buffer_load_dwordx4 v[200:203], v2, s[56:59], s8 offen offset:2048 nt
  buffer_load_dwordx4 v[204:207], v2, s[56:59], s8 offen offset:3072 nt
  s_mov_b64 exec, 1
  v_mov_b32 v90, 1
  ds_add_u32 v89, v90 offset:3092
  s_mov_b64 exec, -1
  buffer_load_dwordx4 v[208:211], v2, s[56:59], s9 offen offset:0 nt
  buffer_load_dwordx4 v[212:215], v2, s[56:59], s9 offen offset:1024 nt
  buffer_load_dwordx4 v[216:219], v2, s[56:59], s9 offen offset:2048 nt
  buffer_load_dwordx4 v[220:223], v2, s[56:59], s9 offen offset:3072 nt
  s_cmp_eq_u32 s16, 0
  s_cbranch_scc1 L_loop
  s_mov_b32 s16, 0
  s_branch L_afterfirst
L_exit_pass:
  s_mov_b64 exec, 1
  v_mov_b32 v90, 1
  ds_add_u32 v89, v90 offset:3092
  s_mov_b64 exec, -1
  s_cmp_eq_u32 s16, 0
  s_cbranch_scc1 L_exit
  s_mov_b32 s16, 2
  s_waitcnt vmcnt(0)
  s_branch L_afterfirst
L_exit:
  s_setprio 3
L_flush:
  v_mov_b32 v9, 1
  s_mov_b64 exec, 1
  ds_add_rtn_u32 v8, v87, v9 offset:3084
  s_mov_b64 exec, -1
  s_mov_b32 s13, 3200000
L_fl_read:
  ds_read_b32 v95, v87 offset:3096
  ds_read_b64 v[228:229], v92 offset:112
  ds_read_b128 v[232:235], v91 offset:7168
  s_waitcnt lgkmcnt(0)
  v_readfirstlane_b32 s17, v8
  v_readfirstlane_b32 s6, v95
  s_cmp_lt_u32 s17, 6
  s_cbranch_scc1 L_fl_write
  s_cmp_eq_u32 s17, s6
  s_cbranch_scc1 L_fl_go
  s_sub_u32 s13, s13, 1
  s_cbranch_scc0 L_fl_read
L_fl_go:
  s_cmp_eq_u32 s17, 7
  s_cbranch_scc1 L_merge
  ds_read_b64 v[128:129], v92 offset:0
  ds_read_b64 v[130:131], v92 offset:16
  ds_read_b64 v[132:133], v92 offset:32
  ds_read_b64 v[134:135], v92 offset:48
  ds_read_b64 v[136:137], v92 offset:64
  ds_read_b64 v[138:139], v92 offset:80
  ds_read_b128 v[96:99], v91 offset:0
  ds_read_b128 v[100:103], v91 offset:1024
  ds_read_b128 v[104:107], v91 offset:2048
  ds_read_b128 v[108:111], v91 offset:3072
  ds_read_b128 v[112:115], v91 offset:4096
  ds_read_b128 v[116:119], v91 offset:5120
  s_waitcnt lgkmcnt(6)
  v_max3_f32 v8, v128, v130, v132
  v_max3_f32 v10, v134, v136, v138
  v_max3_f32 v8, v8, v10, v84
  v_sub_f32 v10, v84, v8
  v_sub_f32 v128, v128, v8
  v_sub_f32 v130, v130, v8
  v_sub_f32 v132, v132, v8
  v_sub_f32 v134, v134, v8
  v_sub_f32 v136, v136, v8
  v_sub_f32 v138, v138, v8
  v_mul_f32 v10, s10, v10
  v_mul_f32 v128, s10, v128
  v_mul_f32 v130, s10, v130
  v_mul_f32 v132, s10, v132
  v_mul_f32 v134, s10, v134
  v_mul_f32 v136, s10, v136
  v_mul_f32 v138, s10, v138
  v_exp_f32 v10, v10
  v_exp_f32 v128, v128
  v_exp_f32 v130, v130
  v_exp_f32 v132, v132
  v_exp_f32 v134, v134
  v_exp_f32 v136, v136
  v_exp_f32 v138, v138
  v_mov_b32 v84, v8
  v_mul_f32 v85, v10, v85
  v_mul_f32 v224, v10, v224
  v_mul_f32 v225, v10, v225
  v_mul_f32 v226, v10, v226
  v_mul_f32 v227, v10, v227
  v_fmac_f32 v85, v128, v129
  v_fmac_f32 v85, v130, v131
  v_fmac_f32 v85, v132, v133
  v_fmac_f32 v85, v134, v135
  v_fmac_f32 v85, v136, v137
  v_fmac_f32 v85, v138, v139
  s_waitcnt lgkmcnt(0)
  v_fmac_f32 v224, v128, v96
  v_fmac_f32 v225, v128, v97
  v_fmac_f32 v226, v128, v98
  v_fmac_f32 v227, v128, v99
  v_fmac_f32 v224, v130, v100
  v_fmac_f32 v225, v130, v101
  v_fmac_f32 v226, v130, v102
  v_fmac_f32 v227, v130, v103
  v_fmac_f32 v224, v132, v104
  v_fmac_f32 v225, v132, v105
  v_fmac_f32 v226, v132, v106
  v_fmac_f32 v227, v132, v107
  v_fmac_f32 v224, v134, v108
  v_fmac_f32 v225, v134, v109
  v_fmac_f32 v226, v134, v110
  v_fmac_f32 v227, v134, v111
  v_fmac_f32 v224, v136, v112
  v_fmac_f32 v225, v136, v113
  v_fmac_f32 v226, v136, v114
  v_fmac_f32 v227, v136, v115
  v_fmac_f32 v224, v138, v116
  v_fmac_f32 v225, v138, v117
  v_fmac_f32 v226, v138, v118
  v_fmac_f32 v227, v138, v119
L_fl_write:
  s_cmp_eq_u32 s17, 6
  s_cselect_b32 s6, 7, s17
  v_lshl_add_u32 v10, s6, 10, v91
  v_lshl_add_u32 v11, s6, 4, v92
  ds_write_b128 v10, v[224:227]
  s_mov_b64 exec, 0x101
  ds_write_b64 v11, v[84:85]
  s_mov_b64 exec, 1
  ds_add_u32 v87, v9 offset:3096
  s_mov_b64 exec, -1
  s_branch L_nocomb
L_merge:
  v_max_f32 v8, v84, v228
  v_sub_f32 v9, v84, v8
  v_sub_f32 v10, v228, v8
  v_mul_f32 v9, s10, v9
  v_mul_f32 v10, s10, v10
  v_exp_f32 v9, v9
  v_exp_f32 v10, v10
  v_mul_f32 v11, v9, v85
  v_fmac_f32 v11, v10, v229
  v_mul_f32 v232, v10, v232
  v_mul_f32 v233, v10, v233
  v_mul_f32 v234, v10, v234
  v_mul_f32 v235, v10, v235
  v_rcp_f32 v10, v11
  v_log_f32 v11, v11
  v_fmac_f32 v232, v9, v224
  v_fmac_f32 v233, v9, v225
  v_fmac_f32 v234, v9, v226
  v_fmac_f32 v235, v9, v227
  v_fma_f32 v230, v8, s10, v11
  v_mul_f32 v232, v10, v232
  v_mul_f32 v233, v10, v233
  v_mul_f32 v234, v10, v234
  v_mul_f32 v235, v10, v235
  v_xor_b32 v231, s100, v230
  v_cvt_pk_bf16_f32 v228, v232, v233
  v_cvt_pk_bf16_f32 v229, v234, v235
  v_bitop3_b32 v231, v228, v229, v231 bitop3:0x96
  s_cmp_eq_u32 s75, 0
  s_cbranch_scc0 L_pubnow
  v_mov_b32 v236, v228
  v_mov_b32 v237, v229
  v_mov_b32 v238, v230
  v_mov_b32 v239, v231
  s_mov_b32 s24, s30
  s_branch L_nocomb
L_pubnow:
  buffer_store_dwordx4 v[228:231], v14, s[68:71], s30 offen sc1
L_nocomb:
  s_waitcnt lgkmcnt(0)
  s_cmp_eq_u32 s75, 0
  s_cbranch_scc1 L_retA
L_tail:
  s_cmp_eq_u32 s24, 0
  s_cbranch_scc1 L_noap
  buffer_store_dwordx4 v[236:239], v14, s[68:71], s24 offen sc1
  s_mov_b32 s24, 0
L_noap:
  s_cmp_lt_u32 s17, 5
  s_cbranch_scc0 L_nowo
  s_setprio 0
  s_and_b32 s7, s15, 7
  s_lshl3_add_u32 s7, s14, s7
  s_mul_i32 s7, s7, 36864
  s_lshl_b32 s6, s17, 8
  s_add_u32 s6, s6, s7
  v_lshrrev_b32 v6, 4, v0
  v_mul_u32_u24 v10, 2304, v6
  v_and_b32 v11, 15, v0
  v_lshl_add_u32 v10, v11, 4, v10
  s_cmp_eq_u32 s17, 4
  s_cselect_b32 vcc_lo, 0xff00ff00, 0
  s_cselect_b32 vcc_hi, 0xff00ff00, 0
  s_cselect_b32 s40, 0, -1
  v_mov_b32 v11, 4718592
  v_cndmask_b32 v10, v10, v11, vcc
  buffer_load_dwordx4 v[160:163], v10, s[64:67], s6 offen offset:0 nt
  buffer_load_dwordx4 v[176:179], v10, s[64:67], s6 offen offset:1152 nt
  s_add_u32 s7, s6, 9216
  buffer_load_dwordx4 v[164:167], v10, s[64:67], s7 offen offset:0 nt
  buffer_load_dwordx4 v[180:183], v10, s[64:67], s7 offen offset:1152 nt
  s_add_u32 s7, s6, 18432
  buffer_load_dwordx4 v[168:171], v10, s[64:67], s7 offen offset:0 nt
  buffer_load_dwordx4 v[184:187], v10, s[64:67], s7 offen offset:1152 nt
  s_add_u32 s7, s6, 27648
  buffer_load_dwordx4 v[172:175], v10, s[64:67], s7 offen offset:0 nt
  buffer_load_dwordx4 v[188:191], v10, s[64:67], s7 offen offset:1152 nt
  s_setprio 3
  v_and_b32 v7, 1, v0
  v_lshlrev_b32 v7, 4, v7
  v_lshl_add_u32 v7, v6, 5, v7
  v_add_u32 v7, 3968, v7
  v_mov_b32 v5, 3104
  v_bfe_u32 v4, v0, 1, 3
  v_cmp_eq_u32 vcc, 0, v4
  s_nop 1
  v_cndmask_b32 v240, v5, v7, vcc
  v_cmp_eq_u32 vcc, 1, v4
  s_nop 1
  v_cndmask_b32 v241, v5, v7, vcc
  v_cmp_eq_u32 vcc, 2, v4
  s_nop 1
  v_cndmask_b32 v242, v5, v7, vcc
  v_cmp_eq_u32 vcc, 3, v4
  s_nop 1
  v_cndmask_b32 v243, v5, v7, vcc
  v_cmp_eq_u32 vcc, 4, v4
  s_nop 1
  v_cndmask_b32 v244, v5, v7, vcc
  v_cmp_eq_u32 vcc, 5, v4
  s_nop 1
  v_cndmask_b32 v245, v5, v7, vcc
  v_cmp_eq_u32 vcc, 6, v4
  s_nop 1
  v_cndmask_b32 v246, v5, v7, vcc
  v_cmp_eq_u32 vcc, 7, v4
  s_nop 1
  v_cndmask_b32 v247, v5, v7, vcc
  s_lshl_b32 s6, s17, 10
  s_mul_i32 s7, s2, 4736
  s_add_u32 s6, s6, s7
  s_add_u32 s31, s6, 884736
  s_mov_b32 s41, 0x07060503
  s_mov_b32 s42, 0x07060502
  s_mov_b32 s43, 0x07060501
  s_waitcnt vmcnt(0)
  v_perm_b32 v192, v164, v160, s11
  v_perm_b32 v193, v172, v168, s11
  v_perm_b32 v194, v180, v176, s11
  v_perm_b32 v195, v188, v184, s11
  v_perm_b32 v196, v164, v160, s12
  v_perm_b32 v197, v172, v168, s12
  v_perm_b32 v198, v180, v176, s12
  v_perm_b32 v199, v188, v184, s12
  v_perm_b32 v200, v165, v161, s11
  v_perm_b32 v201, v173, v169, s11
  v_perm_b32 v202, v181, v177, s11
  v_perm_b32 v203, v189, v185, s11
  v_perm_b32 v204, v165, v161, s12
  v_perm_b32 v205, v173, v169, s12
  v_perm_b32 v206, v181, v177, s12
  v_perm_b32 v207, v189, v185, s12
  v_perm_b32 v208, v166, v162, s11
  v_perm_b32 v209, v174, v170, s11
  v_perm_b32 v210, v182, v178, s11
  v_perm_b32 v211, v190, v186, s11
  v_perm_b32 v212, v166, v162, s12
  v_perm_b32 v213, v174, v170, s12
  v_perm_b32 v214, v182, v178, s12
  v_perm_b32 v215, v190, v186, s12
  v_perm_b32 v216, v167, v163, s11
  v_perm_b32 v217, v175, v171, s11
  v_perm_b32 v218, v183, v179, s11
  v_perm_b32 v219, v191, v187, s11
  v_perm_b32 v220, v167, v163, s12
  v_perm_b32 v221, v175, v171, s12
  v_perm_b32 v222, v183, v179, s12
  v_perm_b32 v223, v191, v187, s12
  s_barrier
  ds_read_b128 v[96:99], v240
  ds_read_b128 v[100:103], v241
  ds_read_b128 v[104:107], v242
  ds_read_b128 v[108:111], v243
  ds_read_b128 v[112:115], v244
  ds_read_b128 v[116:119], v245
  ds_read_b128 v[120:123], v246
  ds_read_b128 v[124:127], v247
  s_waitcnt lgkmcnt(7)
  v_mfma_f32_16x16x32_bf16 v[76:79], v[192:195], v[96:99], 0
  s_waitcnt lgkmcnt(6)
  v_mfma_f32_16x16x32_bf16 v[76:79], v[196:199], v[100:103], v[76:79]
  s_waitcnt lgkmcnt(5)
  v_mfma_f32_16x16x32_bf16 v[76:79], v[200:203], v[104:107], v[76:79]
  s_waitcnt lgkmcnt(4)
  v_mfma_f32_16x16x32_bf16 v[76:79], v[204:207], v[108:111], v[76:79]
  s_waitcnt lgkmcnt(3)
  v_mfma_f32_16x16x32_bf16 v[76:79], v[208:211], v[112:115], v[76:79]
  s_waitcnt lgkmcnt(2)
  v_mfma_f32_16x16x32_bf16 v[76:79], v[212:215], v[116:119], v[76:79]
  s_waitcnt lgkmcnt(1)
  v_mfma_f32_16x16x32_bf16 v[76:79], v[216:219], v[120:123], v[76:79]
  s_waitcnt lgkmcnt(0)
  v_mfma_f32_16x16x32_bf16 v[76:79], v[220:223], v[124:127], v[76:79]
  s_mov_b32 exec_hi, s40
  s_nop 6
  v_perm_b32 v76, v76, v79, s41
  v_perm_b32 v77, v77, v79, s42
  v_perm_b32 v78, v78, v79, s43
  v_bitop3_b32 v79, v76, v77, s100 bitop3:0x96
  v_xor_b32 v79, v79, v78
  buffer_store_dwordx4 v[76:79], v2, s[68:71], s31 offen sc1
  s_mov_b64 exec, -1
  s_branch L_hop2
L_nowo:
  s_cmp_eq_u32 s17, 5
  s_cbranch_scc0 L_bar4
  v_and_b32 v7, 1, v0
  v_lshlrev_b32 v10, 2, v7
  v_lshlrev_b32 v7, 4, v7
  v_lshrrev_b32 v6, 4, v0
  v_lshl_add_u32 v7, v6, 5, v7
  v_and_b32 v4, 15, v0
  v_lshlrev_b32 v4, 7, v4
  v_lshl_add_u32 v4, v6, 5, v4
  s_mul_i32 s6, s2, 2176
  s_add_u32 s6, s6, 131072
  s_mov_b32 s13, 200000
L_poll1:
  buffer_load_dwordx4 v[160:163], v4, s[68:71], s6 offen offset:0 sc1
  buffer_load_dwordx4 v[164:167], v4, s[68:71], s6 offen offset:16 sc1
  s_sub_u32 s13, s13, 1
  s_cbranch_scc1 L_poll1_done
  s_waitcnt vmcnt(1)
  v_bitop3_b32 v8, v160, v161, v162 bitop3:0x96
  v_bitop3_b32 v8, v8, v163, s100 bitop3:0x96
  s_waitcnt vmcnt(0)
  v_bitop3_b32 v9, v164, v165, v166 bitop3:0x96
  v_bitop3_b32 v9, v9, v167, s100 bitop3:0x96
  v_or_b32 v8, v8, v9
  v_cmp_ne_u32 vcc, 0, v8
  s_and_b64 exec, exec, vcc
  s_cbranch_scc1 L_poll1
L_poll1_done:
  s_mov_b64 exec, -1
  s_waitcnt vmcnt(0)
  ds_read_b32 v10, v10 offset:3648
  v_max_f32_dpp v8, v162, v162 row_ror:2 row_mask:0xf bank_mask:0xf
  v_lshlrev_b32 v176, 16, v160
  v_and_b32 v177, 0xffff0000, v160
  v_max_f32_dpp v8, v8, v8 row_ror:4 row_mask:0xf bank_mask:0xf
  v_lshlrev_b32 v178, 16, v161
  v_and_b32 v179, 0xffff0000, v161
  v_max_f32_dpp v8, v8, v8 row_ror:8 row_mask:0xf bank_mask:0xf
  v_lshlrev_b32 v180, 16, v164
  v_sub_f32 v8, v162, v8
  v_exp_f32 v8, v8
  v_and_b32 v181, 0xffff0000, v164
  v_lshlrev_b32 v182, 16, v165
  v_and_b32 v183, 0xffff0000, v165
  v_add_f32_dpp v9, v8, v8 row_ror:2 row_mask:0xf bank_mask:0xf
  v_mul_f32 v176, v8, v176
  v_mul_f32 v177, v8, v177
  v_add_f32_dpp v9, v9, v9 row_ror:4 row_mask:0xf bank_mask:0xf
  v_mul_f32 v178, v8, v178
  v_mul_f32 v179, v8, v179
  v_add_f32_dpp v9, v9, v9 row_ror:8 row_mask:0xf bank_mask:0xf
  v_mul_f32 v180, v8, v180
  v_rcp_f32 v9, v9
  v_mul_f32 v181, v8, v181
  v_mul_f32 v182, v8, v182
  v_mul_f32 v183, v8, v183
  v_add_f32_dpp v176, v176, v176 row_ror:2 row_mask:0xf bank_mask:0xf
  v_add_f32_dpp v177, v177, v177 row_ror:2 row_mask:0xf bank_mask:0xf
  v_add_f32_dpp v178, v178, v178 row_ror:2 row_mask:0xf bank_mask:0xf
  v_add_f32_dpp v179, v179, v179 row_ror:2 row_mask:0xf bank_mask:0xf
  v_add_f32_dpp v180, v180, v180 row_ror:2 row_mask:0xf bank_mask:0xf
  v_add_f32_dpp v181, v181, v181 row_ror:2 row_mask:0xf bank_mask:0xf
  v_add_f32_dpp v182, v182, v182 row_ror:2 row_mask:0xf bank_mask:0xf
  v_add_f32_dpp v183, v183, v183 row_ror:2 row_mask:0xf bank_mask:0xf
  s_waitcnt lgkmcnt(0)
  v_mul_f32 v9, v9, v10
  v_add_f32_dpp v176, v176, v176 row_ror:4 row_mask:0xf bank_mask:0xf
  v_add_f32_dpp v177, v177, v177 row_ror:4 row_mask:0xf bank_mask:0xf
  v_add_f32_dpp v178, v178, v178 row_ror:4 row_mask:0xf bank_mask:0xf
  v_add_f32_dpp v179, v179, v179 row_ror:4 row_mask:0xf bank_mask:0xf
  v_add_f32_dpp v180, v180, v180 row_ror:4 row_mask:0xf bank_mask:0xf
  v_add_f32_dpp v181, v181, v181 row_ror:4 row_mask:0xf bank_mask:0xf
  v_add_f32_dpp v182, v182, v182 row_ror:4 row_mask:0xf bank_mask:0xf
  v_add_f32_dpp v183, v183, v183 row_ror:4 row_mask:0xf bank_mask:0xf
  v_add_f32_dpp v176, v176, v176 row_ror:8 row_mask:0xf bank_mask:0xf
  v_add_f32_dpp v177, v177, v177 row_ror:8 row_mask:0xf bank_mask:0xf
  v_add_f32_dpp v178, v178, v178 row_ror:8 row_mask:0xf bank_mask:0xf
  v_add_f32_dpp v179, v179, v179 row_ror:8 row_mask:0xf bank_mask:0xf
  v_add_f32_dpp v180, v180, v180 row_ror:8 row_mask:0xf bank_mask:0xf
  v_add_f32_dpp v181, v181, v181 row_ror:8 row_mask:0xf bank_mask:0xf
  v_add_f32_dpp v182, v182, v182 row_ror:8 row_mask:0xf bank_mask:0xf
  v_add_f32_dpp v183, v183, v183 row_ror:8 row_mask:0xf bank_mask:0xf
  v_mul_f32 v176, v9, v176
  v_mul_f32 v177, v9, v177
  v_mul_f32 v178, v9, v178
  v_mul_f32 v179, v9, v179
  v_mul_f32 v180, v9, v180
  v_mul_f32 v181, v9, v181
  v_mul_f32 v182, v9, v182
  v_mul_f32 v183, v9, v183
  v_cvt_pk_bf16_f32 v168, v176, v177
  v_cvt_pk_bf16_f32 v169, v178, v179
  v_cvt_pk_bf16_f32 v170, v180, v181
  v_cvt_pk_bf16_f32 v171, v182, v183
  s_mov_b32 exec_lo, 0x00030003
  s_mov_b32 exec_hi, 0x00030003
  ds_write_b128 v7, v[168:171] offset:3968
  s_mov_b64 exec, -1
L_bar4:
  s_waitcnt lgkmcnt(0)
  s_barrier
L_hop2:
  s_and_b32 s6, s2, 7
  s_lshl3_add_u32 s19, s14, s6
  s_bitcmp1_b32 s2, 3
  s_cbranch_scc0 L_fin
  s_cmp_ge_u32 s19, 72
  s_cbranch_scc1 L_fin
  s_and_b32 s7, s14, 6
  s_lshl2_add_u32 s7, s7, s6
  s_and_b32 s8, s14, 1
  s_lshl1_add_u32 s7, s7, s8
  s_cmp_lt_u32 s19, 64
  s_cselect_b32 s19, s7, s19
  s_setprio 0
  v_lshrrev_b32 v4, 2, v0
  v_mul_u32_u24 v4, 4736, v4
  v_and_b32 v5, 3, v0
  v_lshl_add_u32 v4, v5, 4, v4
  s_mul_i32 s6, s3, 151552
  s_lshl_b32 s7, s19, 6
  s_add_u32 s6, s6, s7
  s_add_u32 s6, s6, 884736
  s_add_u32 s7, s6, 75776
  v_lshrrev_b32 v6, 4, v0
  v_lshl_add_u32 v6, v6, 2, v5
  v_lshlrev_b32 v6, 2, v6
  v_lshl_add_u32 v6, s3, 6, v6
  s_mov_b32 s76, s38
  s_mov_b32 s77, s39
  s_mov_b32 s78, 2304
  s_mov_b32 s79, 0x00020000
  s_lshr_b32 s8, s19, 2
  s_lshl_b32 s8, s8, 5
  s_and_b32 s9, s19, 3
  s_lshl1_add_u32 s8, s9, s8
  v_and_b32 v7, 12, v0
  v_lshl_add_u32 v7, v7, 1, s8
  v_bfe_u32 v10, v0, 1, 1
  v_add_u32 v7, v7, v10
  v_and_b32 v10, 1, v0
  v_mul_u32_u24 v10, 576, v10
  v_add_lshl_u32 v7, v7, v10, 1
  v_lshlrev_b32 v11, 2, v0
  s_mov_b32 s8, 0x0400040c
  s_mov_b32 s9, 0x0706000c
  s_sleep 8
  s_mov_b32 s13, 200000
L_poll2:
  buffer_load_dwordx4 v[32:35], v4, s[68:71], s6 offen sc1
  buffer_load_dwordx4 v[36:39], v4, s[68:71], s7 offen sc1
  s_sub_u32 s13, s13, 1
  s_cbranch_scc1 L_poll2_done
  s_waitcnt vmcnt(1)
  v_bitop3_b32 v8, v32, v33, v34 bitop3:0x96
  v_bitop3_b32 v8, v8, v35, s100 bitop3:0x96
  s_waitcnt vmcnt(0)
  v_bitop3_b32 v9, v36, v37, v38 bitop3:0x96
  v_bitop3_b32 v9, v9, v39, s100 bitop3:0x96
  v_or_b32 v8, v8, v9
  v_cmp_ne_u32 vcc, 0, v8
  s_and_b64 exec, exec, vcc
  s_cbranch_scc1 L_poll2
L_poll2_done:
  s_mov_b64 exec, -1
  s_waitcnt vmcnt(0)
  s_setprio 3
  v_perm_b32 v35, v32, v33, s8
  v_perm_b32 v35, v35, v34, s9
  v_perm_b32 v39, v36, v37, s8
  v_perm_b32 v39, v39, v38, s9
  v_add_f32 v32, v32, v36
  v_add_f32 v33, v33, v37
  v_add_f32 v34, v34, v38
  v_add_f32 v35, v35, v39
  s_nop 0
  v_permlane32_swap_b32 v32, v34
  v_permlane32_swap_b32 v33, v35
  v_add_f32 v32, v32, v34
  v_add_f32 v33, v33, v35
  s_nop 1
  v_permlane16_swap_b32 v32, v33
  v_add_f32 v32, v32, v33
  s_nop 1
  v_add_f32_dpp v32, v32, v32 row_ror:8 row_mask:0xf bank_mask:0xf
  s_nop 1
  v_add_f32_dpp v32, v32, v32 row_ror:4 row_mask:0xf bank_mask:0xf
  s_cmp_eq_u32 s3, 0
  ds_write_b32 v6, v32 offset:3120
  s_waitcnt lgkmcnt(0)
  s_barrier
  s_cbranch_scc0 L_fin
  s_mov_b64 exec, 0xffff
  ds_read_b32 v32, v11 offset:3120
  ds_read_b32 v33, v11 offset:3184
  ds_read_b32 v34, v11 offset:3248
  ds_read_b32 v35, v11 offset:3312
  ds_read_b32 v36, v11 offset:3376
  ds_read_b32 v37, v11 offset:3440
  ds_read_b32 v38, v11 offset:3504
  ds_read_b32 v39, v11 offset:3568
  v_mov_b32 v9, s100
  s_cmp_eq_u32 s19, 0
  s_waitcnt lgkmcnt(0)
  v_add_f32 v32, v32, v36
  v_add_f32 v33, v33, v37
  v_add_f32 v34, v34, v38
  v_add_f32 v35, v35, v39
  v_add_f32 v32, v32, v34
  v_add_f32 v33, v33, v35
  v_add_f32 v32, v32, v33
  v_cvt_pk_bf16_f32 v8, v32, v32
  buffer_store_short v8, v7, s[76:79], 0 offen
  s_cbranch_scc0 L_fin
  s_mov_b64 exec, 1
  buffer_store_dword v9, off, s[68:71], 0 offset:0
L_fin:
L_end:
  s_endpgm
.section .rodata,"a"
.p2align 6
.amdhsa_kernel gated_mix__sliding_block_cached__gqa_block_cached__decode_kernel
  .amdhsa_next_free_vgpr 256
  .amdhsa_next_free_sgpr 102
  .amdhsa_accum_offset 256
  .amdhsa_group_segment_fixed_size 0
  .amdhsa_kernarg_size 112
  .amdhsa_user_sgpr_count 2
  .amdhsa_user_sgpr_kernarg_segment_ptr 1
  .amdhsa_system_sgpr_workgroup_id_x 1
.end_amdhsa_kernel
```
